```python
import torch

def _softmax(x, axis=-1):
    return torch.softmax(x, dim=axis)
def _gelu(x):
    return torch.nn.functional.gelu(x, approximate="tanh")
def _silu(x):
    return torch.nn.functional.silu(x)
def _sigmoid(x):
    return torch.sigmoid(x)
def _layernorm(x, axis=-1, eps=1e-5):
    m = x.mean(dim=axis, keepdim=True)
    v = x.var(dim=axis, keepdim=True, unbiased=False)
    return (x - m) / torch.sqrt(v + eps)
def _scatter_add(tgt, idx, src, axis=0):
    return tgt.clone().index_add_(axis, idx, src)
def _segment_sum(src, seg, n):
    out = torch.zeros((n,) + src.shape[1:], dtype=src.dtype)
    return out.index_add_(0, seg, src)
def _pad(x, pw):
    flat = tuple(v for pair in reversed(pw) for v in pair)
    return torch.nn.functional.pad(x, flat)

kernel_name = 'standalone__mpnn_edge_mlp__graph'

def setup_inputs():

    _w = (lambda a: (lambda t: t.to(torch.bfloat16) if t.is_floating_point() else t)(torch.as_tensor(a)))
    N, deg, D, De = 50000, 16, 64, max(16, 1)
    E = N * deg
    return {
        "x": _w((lambda *s: torch.randn(*s, dtype=torch.bfloat16) * 0.05)(N, D)),
        "e_attr": _w((lambda *s: torch.randn(*s, dtype=torch.bfloat16) * 0.4)(E, De)),
        "src": _w((lambda lo, hi, *s: torch.randint(lo, hi, s))(0, N, E).to(torch.int64)),
        "dst": _w((lambda lo, hi, *s: torch.randint(lo, hi, s))(0, N, E).to(torch.int64)),
        "w_msg": _w((lambda *s: torch.randn(*s, dtype=torch.bfloat16) * 0.4)(2 * D + De, D)),
        "w_upd": _w((lambda *s: torch.randn(*s, dtype=torch.bfloat16) * 0.05)(2 * D, D)),
    }

def reference(x, e_attr, src, dst, w_msg, w_upd):
    N, D = x.shape
    m_in = torch.concatenate([x[src], x[dst], e_attr], axis=-1)
    msg = _silu(m_in @ w_msg)
    agg = _segment_sum(msg, dst, N)
    return _silu(torch.concatenate([x, agg], axis=-1) @ w_upd)
```

```asm
; @launch grid=(256,1,1) block=(512,1,1) lds=162656
.amdgcn_target "amdgcn-amd-amdhsa--gfx950"
.text
.globl standalone__mpnn_edge_mlp__graph_kernel
.p2align 8
.type standalone__mpnn_edge_mlp__graph_kernel,@function
standalone__mpnn_edge_mlp__graph_kernel:
    s_cmp_ge_u32 s2, 256
    s_cbranch_scc1 L_end
    s_load_dwordx8 s[4:11], s[0:1], 0
    s_load_dwordx8 s[68:75], s[0:1], 32
    s_load_dwordx2 s[76:77], s[0:1], 64
    v_lshrrev_b32 v2, 6, v0
    v_and_b32 v1, 63, v0
    v_lshlrev_b32 v30, 4, v0
    v_readfirstlane_b32 s12, v2
    s_mul_i32 s15, s2, 12800
    s_add_u32 s14, s15, 6400
    s_movk_i32 s3, 400
    v_cmp_gt_u32 vcc, s3, v0
    v_mov_b32 v255, 0x7f000000
    s_cmp_lt_u32 s2, 250
    s_cselect_b64 s[44:45], vcc, 0
    v_cndmask_b32 v5, v255, v30, vcc
    v_lshlrev_b32 v31, 4, v1
    v_mov_b32 v29, 0
    v_and_b32 v2, 255, v0
    v_lshlrev_b32 v2, 2, v2
    v_add_u32 v2, 0, v2
    ds_write_b32 v2, v29
    v_and_b32 v2, 31, v0
    v_lshlrev_b32 v2, 2, v2
    v_add_u32 v2, 162528, v2
    ds_write_b32 v2, v29
    s_waitcnt lgkmcnt(0)
    s_mov_b32 s24, s10
    s_mov_b32 s25, s11
    s_mov_b32 s26, 0x30d400
    s_mov_b32 s27, 0x20000
    s_mov_b32 s28, s8
    s_mov_b32 s29, s9
    s_mov_b32 s30, 0x30d400
    s_mov_b32 s31, 0x20000
    buffer_load_dwordx4 v[152:155], v5, s[24:27], s15 offen nt
    buffer_load_dwordx4 v[156:159], v5, s[24:27], s14 offen nt
    buffer_load_dwordx4 v[160:163], v5, s[28:31], s15 offen nt
    buffer_load_dwordx4 v[164:167], v5, s[28:31], s14 offen nt
    s_add_u32 s8, s76, 0x7c0000
    s_addc_u32 s9, s77, 0
    s_load_dword s10, s[8:9], 0
    s_mov_b32 s33, 175921861
    s_movk_i32 s34, 3125
    v_mov_b32 v14, 1
    v_mov_b32 v15, 127
    s_mov_b32 s35, 0
    s_mov_b32 s24, s76
    s_mov_b32 s25, s77
    s_mov_b32 s26, 0x61a800
    s_mov_b32 s27, 0x20000
    s_add_u32 s28, s76, 0x700000
    s_addc_u32 s29, s77, 0
    s_mov_b32 s30, 0x80000
    s_mov_b32 s31, 0x20000
    s_waitcnt lgkmcnt(0)
    s_barrier
    s_mul_i32 s3, s2, 102400
    v_lshlrev_b32 v5, 7, v0
    v_add_u32 v5, s3, v5
    s_add_u32 s10, s10, 1
    s_waitcnt vmcnt(2)
    s_mov_b64 exec, s[44:45]
    v_mul_hi_u32 v168, v152, s33
    v_mul_hi_u32 v169, v153, s33
    v_mul_hi_u32 v170, v154, s33
    v_mul_hi_u32 v171, v155, s33
    v_mul_hi_u32 v172, v156, s33
    v_mul_hi_u32 v173, v157, s33
    v_mul_hi_u32 v174, v158, s33
    v_mul_hi_u32 v175, v159, s33
    v_lshrrev_b32 v184, 1, v168
    v_and_b32 v184, 0x3fc, v184
    v_add_u32 v184, s35, v184
    ds_add_rtn_u32 v192, v184, v14
    v_lshrrev_b32 v185, 1, v169
    v_and_b32 v185, 0x3fc, v185
    v_add_u32 v185, s35, v185
    ds_add_rtn_u32 v193, v185, v14
    v_lshrrev_b32 v186, 1, v170
    v_and_b32 v186, 0x3fc, v186
    v_add_u32 v186, s35, v186
    ds_add_rtn_u32 v194, v186, v14
    v_lshrrev_b32 v187, 1, v171
    v_and_b32 v187, 0x3fc, v187
    v_add_u32 v187, s35, v187
    ds_add_rtn_u32 v195, v187, v14
    v_lshrrev_b32 v188, 1, v172
    v_and_b32 v188, 0x3fc, v188
    v_add_u32 v188, s35, v188
    ds_add_rtn_u32 v196, v188, v14
    v_lshrrev_b32 v189, 1, v173
    v_and_b32 v189, 0x3fc, v189
    v_add_u32 v189, s35, v189
    ds_add_rtn_u32 v197, v189, v14
    v_lshrrev_b32 v190, 1, v174
    v_and_b32 v190, 0x3fc, v190
    v_add_u32 v190, s35, v190
    ds_add_rtn_u32 v198, v190, v14
    v_lshrrev_b32 v191, 1, v175
    v_and_b32 v191, 0x3fc, v191
    v_add_u32 v191, s35, v191
    ds_add_rtn_u32 v199, v191, v14
    v_mad_u32_u24 v2, v168, s34, v15
    v_lshrrev_b32 v2, 7, v2
    v_sub_u32 v2, v152, v2
    v_add_u32 v2, 0, v2
    v_add_u32 v201, v5, v2
    v_and_b32 v168, 7, v168
    v_lshlrev_b32 v168, 2, v168
    v_mad_u32_u24 v2, v169, s34, v15
    v_lshrrev_b32 v2, 7, v2
    v_sub_u32 v2, v153, v2
    v_add_u32 v2, 32, v2
    v_add_u32 v203, v5, v2
    v_and_b32 v169, 7, v169
    v_lshlrev_b32 v169, 2, v169
    v_mad_u32_u24 v2, v170, s34, v15
    v_lshrrev_b32 v2, 7, v2
    v_sub_u32 v2, v154, v2
    v_add_u32 v2, 64, v2
    v_add_u32 v205, v5, v2
    v_and_b32 v170, 7, v170
    v_lshlrev_b32 v170, 2, v170
    v_mad_u32_u24 v2, v171, s34, v15
    v_lshrrev_b32 v2, 7, v2
    v_sub_u32 v2, v155, v2
    v_add_u32 v2, 96, v2
    v_add_u32 v207, v5, v2
    v_and_b32 v171, 7, v171
    v_lshlrev_b32 v171, 2, v171
    v_mad_u32_u24 v2, v172, s34, v15
    v_lshrrev_b32 v2, 7, v2
    v_sub_u32 v2, v156, v2
    v_add_u32 v2, 51200, v2
    v_add_u32 v209, v5, v2
    v_and_b32 v172, 7, v172
    v_lshlrev_b32 v172, 2, v172
    v_mad_u32_u24 v2, v173, s34, v15
    v_lshrrev_b32 v2, 7, v2
    v_sub_u32 v2, v157, v2
    v_add_u32 v2, 51232, v2
    v_add_u32 v211, v5, v2
    v_and_b32 v173, 7, v173
    v_lshlrev_b32 v173, 2, v173
    v_mad_u32_u24 v2, v174, s34, v15
    v_lshrrev_b32 v2, 7, v2
    v_sub_u32 v2, v158, v2
    v_add_u32 v2, 51264, v2
    v_add_u32 v213, v5, v2
    v_and_b32 v174, 7, v174
    v_lshlrev_b32 v174, 2, v174
    v_mad_u32_u24 v2, v175, s34, v15
    v_lshrrev_b32 v2, 7, v2
    v_sub_u32 v2, v159, v2
    v_add_u32 v2, 51296, v2
    v_add_u32 v215, v5, v2
    v_and_b32 v175, 7, v175
    v_lshlrev_b32 v175, 2, v175
    s_waitcnt vmcnt(0)
    v_lshl_or_b32 v200, v160, 7, v168
    v_lshl_or_b32 v202, v161, 7, v169
    v_lshl_or_b32 v204, v162, 7, v170
    v_lshl_or_b32 v206, v163, 7, v171
    v_lshl_or_b32 v208, v164, 7, v172
    v_lshl_or_b32 v210, v165, 7, v173
    v_lshl_or_b32 v212, v166, 7, v174
    v_lshl_or_b32 v214, v167, 7, v175
    s_mov_b64 exec, -1
    s_mov_b32 s32, s68
    s_mov_b32 s33, s69
    s_mov_b32 s34, 0x4800
    s_mov_b32 s35, 0x20000
    s_mov_b32 s16, s4
    s_mov_b32 s17, s5
    s_mov_b32 s18, 0x61a800
    s_mov_b32 s19, 0x20000
    s_mov_b32 s20, s6
    s_mov_b32 s21, s7
    s_mov_b32 s22, 0x186a000
    s_mov_b32 s23, 0x20000
    s_lshl_b32 s38, s12, 10
    s_add_u32 s39, s38, 0
    s_add_u32 m0, s39, 32768
    s_nop 0
    buffer_load_dwordx4 v31, s[32:35], s39 offen lds
    s_add_u32 s39, s38, 8192
    s_add_u32 m0, s39, 32768
    s_nop 0
    buffer_load_dwordx4 v31, s[32:35], s39 offen lds
    s_add_u32 s39, s38, 16384
    s_add_u32 m0, s39, 32768
    s_nop 0
    buffer_load_dwordx4 v31, s[32:35], s39 offen lds
    s_and_b32 s13, s2, 7
    s_lshl_b32 s13, s13, 5
    s_lshr_b32 s14, s2, 3
    s_add_u32 s13, s13, s14
    v_and_b32 v3, 31, v1
    v_lshrrev_b32 v4, 5, v1
    s_lshl_b32 s15, s13, 3
    s_add_u32 s15, s15, s12
    s_mul_i32 s36, s15, 3125
    s_add_u32 s37, s36, 3252
    s_add_u32 s36, s36, 127
    s_lshr_b32 s36, s36, 7
    s_lshr_b32 s37, s37, 7
    s_sub_u32 s37, s37, s36
    s_lshl_b32 s36, s36, 7
    v_lshlrev_b32 v7, 7, v3
    v_lshlrev_b32 v22, 4, v4
    v_add_u32 v6, v7, v22
    s_mov_b32 s32, s70
    s_mov_b32 s33, s71
    s_mov_b32 s34, 0x4000
    s_mov_b32 s35, 0x20000
    s_add_u32 s39, s38, 0
    s_add_u32 m0, s39, 131072
    s_nop 0
    buffer_load_dwordx4 v31, s[32:35], s39 offen lds
    s_add_u32 s39, s38, 8192
    s_add_u32 m0, s39, 131072
    s_nop 0
    buffer_load_dwordx4 v31, s[32:35], s39 offen lds
    v_add_u32 v2, 0, v31
    s_waitcnt lgkmcnt(0)
    s_barrier
    ds_read_b128 v[40:43], v2
    s_waitcnt lgkmcnt(0)
    v_add_u32 v45, v40, v41
    v_add_u32 v46, v45, v42
    v_add_u32 v47, v46, v43
    v_mov_b32 v44, v47
    s_nop 1
    v_add_u32_dpp v44, v44, v44 row_shr:1 row_mask:0xf bank_mask:0xf
    s_nop 1
    v_add_u32_dpp v44, v44, v44 row_shr:2 row_mask:0xf bank_mask:0xf
    s_nop 1
    v_add_u32_dpp v44, v44, v44 row_shr:4 row_mask:0xf bank_mask:0xf
    s_nop 1
    v_add_u32_dpp v44, v44, v44 row_shr:8 row_mask:0xf bank_mask:0xf
    s_nop 1
    v_add_u32_dpp v44, v44, v44 row_bcast:15 row_mask:0xa bank_mask:0xf
    s_nop 1
    v_add_u32_dpp v44, v44, v44 row_bcast:31 row_mask:0xc bank_mask:0xf
    v_sub_u32 v36, v44, v47
    v_add_u32 v37, v36, v40
    v_add_u32 v38, v36, v45
    v_add_u32 v39, v36, v46
    ds_write_b128 v2, v[36:39] offset:1024
    s_mov_b64 exec, s[44:45]
    ds_read_b32 v168, v184 offset:1024
    ds_read_b32 v169, v185 offset:1024
    ds_read_b32 v170, v186 offset:1024
    ds_read_b32 v171, v187 offset:1024
    ds_read_b32 v172, v188 offset:1024
    ds_read_b32 v173, v189 offset:1024
    ds_read_b32 v174, v190 offset:1024
    ds_read_b32 v175, v191 offset:1024
    s_mov_b64 exec, -1
    s_mov_b64 exec, s[44:45]
    s_waitcnt lgkmcnt(0)
    v_add_lshl_u32 v168, v168, v192, 3
    ds_write_b64 v168, v[200:201] offset:2048
    v_add_lshl_u32 v169, v169, v193, 3
    ds_write_b64 v169, v[202:203] offset:2048
    v_add_lshl_u32 v170, v170, v194, 3
    ds_write_b64 v170, v[204:205] offset:2048
    v_add_lshl_u32 v171, v171, v195, 3
    ds_write_b64 v171, v[206:207] offset:2048
    v_add_lshl_u32 v172, v172, v196, 3
    ds_write_b64 v172, v[208:209] offset:2048
    v_add_lshl_u32 v173, v173, v197, 3
    ds_write_b64 v173, v[210:211] offset:2048
    v_add_lshl_u32 v174, v174, v198, 3
    ds_write_b64 v174, v[212:213] offset:2048
    v_add_lshl_u32 v175, v175, v199, 3
    ds_write_b64 v175, v[214:215] offset:2048
    s_mov_b64 exec, -1
    s_mov_b32 s78, s72
    s_mov_b32 s79, s73
    v_cmp_gt_u32 vcc, 64, v0
    s_mul_i32 s3, s2, 25600
    s_nop 0
    v_cndmask_b32 v5, v255, v30, vcc
    s_waitcnt lgkmcnt(0)
    s_barrier
    ds_read_b128 v[152:155], v30 offset:2048
    ds_read_b128 v[156:159], v30 offset:10240
    ds_read_b128 v[160:163], v30 offset:18432
    ds_read_b128 v[164:167], v30 offset:26624
    s_waitcnt lgkmcnt(3)
    buffer_store_dwordx4 v[152:155], v30, s[24:27], s3 offen sc1
    s_add_u32 s3, s3, 8192
    s_waitcnt lgkmcnt(2)
    buffer_store_dwordx4 v[156:159], v30, s[24:27], s3 offen sc1
    s_add_u32 s3, s3, 8192
    s_waitcnt lgkmcnt(1)
    buffer_store_dwordx4 v[160:163], v30, s[24:27], s3 offen sc1
    s_add_u32 s3, s3, 8192
    s_waitcnt lgkmcnt(0)
    buffer_store_dwordx4 v[164:167], v5, s[24:27], s3 offen sc1
    s_add_u32 s3, s3, 8192
    v_and_b32 v2, 127, v0
    v_lshlrev_b32 v2, 3, v2
    ds_read_b64 v[40:41], v2 offset:0
    ds_read_b64 v[42:43], v2 offset:1024
    v_mov_b32 v33, s10
    v_mov_b32 v35, s10
    s_lshl_b32 s3, s2, 11
    s_waitcnt lgkmcnt(0)
    v_lshl_or_b32 v32, v40, 16, v42
    v_lshl_or_b32 v34, v41, 16, v43
    s_waitcnt vmcnt(0)
    s_barrier
    s_cmp_ge_u32 s12, 2
    s_cbranch_scc1 L_noflag
    buffer_store_dwordx4 v[32:35], v30, s[28:31], s3 offen sc1
L_noflag:
    s_mul_i32 s41, s12, 12288
    v_bfe_u32 v2, v3, 1, 3
    v_add_u32 v252, 0, v4
    v_xor_b32 v252, v252, v2
    v_lshl_add_u32 v16, v252, 4, v7
    v_add_u32 v16, s41, v16
    v_add_u32 v252, 2, v4
    v_xor_b32 v252, v252, v2
    v_lshl_add_u32 v17, v252, 4, v7
    v_add_u32 v17, s41, v17
    v_add_u32 v252, 4, v4
    v_xor_b32 v252, v252, v2
    v_lshl_add_u32 v18, v252, 4, v7
    v_add_u32 v18, s41, v18
    v_add_u32 v252, 6, v4
    v_xor_b32 v252, v252, v2
    v_lshl_add_u32 v19, v252, 4, v7
    v_add_u32 v19, s41, v19
    v_and_b32 v252, 7, v1
    v_lshrrev_b32 v253, 4, v1
    v_xor_b32 v252, v252, v253
    v_lshlrev_b32 v20, 4, v252
    v_xor_b32 v21, 64, v20
    v_mov_b32 v28, 0x3f80
    s_mul_i32 s42, s12, 1664
    s_add_u32 s42, s42, 147456
    s_movk_i32 s43, 416
    v_mul_u32_u24 v252, s43, v4
    v_add_u32 v25, 160768, v252
    v_lshl_add_u32 v27, v3, 4, v252
    v_add_u32 v27, s42, v27
    v_lshrrev_b32 v252, 4, v3
    v_bfe_u32 v253, v3, 2, 1
    v_lshl_add_u32 v252, v252, 1, v253
    v_mul_u32_u24 v252, s43, v252
    v_and_b32 v253, 8, v3
    v_and_b32 v254, 3, v3
    v_lshl_add_u32 v253, v254, 1, v253
    v_add3_u32 v26, v252, v253, s42
    s_mov_b32 s60, 0xbfb8aa3b
    s_mov_b32 s61, 0xbfb8aa3b
    s_mov_b32 s62, 1.0
    s_mov_b32 s63, 1.0
    s_mov_b32 s64, 0xffffff80
    s_mov_b32 s65, 0xffffffe0
    s_mov_b32 s50, 0
    s_mov_b32 s51, 32
    s_mov_b32 s52, 1
    s_mov_b32 s53, 0
    s_mov_b32 s56, 162528
    s_movk_i32 s57, 512
    v_bfe_u32 v252, v1, 2, 2
    v_lshl_add_u32 v252, v4, 3, v252
    v_lshlrev_b32 v252, 7, v252
    v_and_b32 v253, 16, v1
    v_lshl_add_u32 v252, v253, 1, v252
    v_and_b32 v253, 3, v1
    v_lshl_add_u32 v252, v253, 3, v252
    v_add_u32 v252, 32768, v252
    s_waitcnt lgkmcnt(2)
    ds_read_b64_tr_b16 v[64:65], v252 offset:0
    ds_read_b64_tr_b16 v[66:67], v252 offset:512
    ds_read_b64_tr_b16 v[68:69], v252 offset:64
    ds_read_b64_tr_b16 v[70:71], v252 offset:576
    ds_read_b64_tr_b16 v[72:73], v252 offset:2048
    ds_read_b64_tr_b16 v[74:75], v252 offset:2560
    ds_read_b64_tr_b16 v[76:77], v252 offset:2112
    ds_read_b64_tr_b16 v[78:79], v252 offset:2624
    ds_read_b64_tr_b16 v[80:81], v252 offset:4096
    ds_read_b64_tr_b16 v[82:83], v252 offset:4608
    ds_read_b64_tr_b16 v[84:85], v252 offset:4160
    ds_read_b64_tr_b16 v[86:87], v252 offset:4672
    s_waitcnt lgkmcnt(2)
    ds_read_b64_tr_b16 v[88:89], v252 offset:6144
    ds_read_b64_tr_b16 v[90:91], v252 offset:6656
    ds_read_b64_tr_b16 v[92:93], v252 offset:6208
    ds_read_b64_tr_b16 v[94:95], v252 offset:6720
    ds_read_b64_tr_b16 v[120:121], v252 offset:8192
    ds_read_b64_tr_b16 v[122:123], v252 offset:8704
    ds_read_b64_tr_b16 v[124:125], v252 offset:8256
    ds_read_b64_tr_b16 v[126:127], v252 offset:8768
    ds_read_b64_tr_b16 v[128:129], v252 offset:10240
    ds_read_b64_tr_b16 v[130:131], v252 offset:10752
    ds_read_b64_tr_b16 v[132:133], v252 offset:10304
    ds_read_b64_tr_b16 v[134:135], v252 offset:10816
    s_waitcnt lgkmcnt(2)
    ds_read_b64_tr_b16 v[136:137], v252 offset:12288
    ds_read_b64_tr_b16 v[138:139], v252 offset:12800
    ds_read_b64_tr_b16 v[140:141], v252 offset:12352
    ds_read_b64_tr_b16 v[142:143], v252 offset:12864
    ds_read_b64_tr_b16 v[144:145], v252 offset:14336
    ds_read_b64_tr_b16 v[146:147], v252 offset:14848
    ds_read_b64_tr_b16 v[148:149], v252 offset:14400
    ds_read_b64_tr_b16 v[150:151], v252 offset:14912
    ds_read_b64_tr_b16 v[96:97], v252 offset:16384
    ds_read_b64_tr_b16 v[98:99], v252 offset:16896
    ds_read_b64_tr_b16 v[100:101], v252 offset:16448
    ds_read_b64_tr_b16 v[102:103], v252 offset:16960
    s_waitcnt lgkmcnt(0)
    v_mov_b32 v32, 0
    v_mov_b32 v33, 0
    v_mov_b32 v34, 0
    v_mov_b32 v35, 0
    v_add_u32 v254, s42, v31
    ds_write_b128 v254, v[32:35]
    v_cmp_gt_u32 vcc, 40, v1
    s_mov_b64 exec, vcc
    ds_write_b128 v254, v[32:35] offset:1024
    s_mov_b64 exec, -1
    s_cmp_lg_u32 s12, 7
    s_cbranch_scc1 L_nolut
    ds_write_b128 v254, v[32:35] offset:1664
    s_mov_b64 exec, vcc
    ds_write_b128 v254, v[32:35] offset:2688
    v_cmpx_gt_u32 vcc, 26, v1
    v_lshl_add_u32 v254, v3, 4, v26
    ds_write_b16 v254, v28 offset:1664
    s_mov_b64 exec, -1
L_nolut:
    s_mov_b32 s3, 0xffff0000
    v_lshlrev_b32 v32, 16, v64
    v_and_b32 v33, s3, v64
    v_pk_mul_f32 v[32:33], v[32:33], s[60:61]
    v_cvt_pk_bf16_f32 v64, v32, v33
    v_lshlrev_b32 v32, 16, v65
    v_and_b32 v33, s3, v65
    v_pk_mul_f32 v[32:33], v[32:33], s[60:61]
    v_cvt_pk_bf16_f32 v65, v32, v33
    v_lshlrev_b32 v32, 16, v66
    v_and_b32 v33, s3, v66
    v_pk_mul_f32 v[32:33], v[32:33], s[60:61]
    v_cvt_pk_bf16_f32 v66, v32, v33
    v_lshlrev_b32 v32, 16, v67
    v_and_b32 v33, s3, v67
    v_pk_mul_f32 v[32:33], v[32:33], s[60:61]
    v_cvt_pk_bf16_f32 v67, v32, v33
    v_lshlrev_b32 v32, 16, v68
    v_and_b32 v33, s3, v68
    v_pk_mul_f32 v[32:33], v[32:33], s[60:61]
    v_cvt_pk_bf16_f32 v68, v32, v33
    v_lshlrev_b32 v32, 16, v69
    v_and_b32 v33, s3, v69
    v_pk_mul_f32 v[32:33], v[32:33], s[60:61]
    v_cvt_pk_bf16_f32 v69, v32, v33
    v_lshlrev_b32 v32, 16, v70
    v_and_b32 v33, s3, v70
    v_pk_mul_f32 v[32:33], v[32:33], s[60:61]
    v_cvt_pk_bf16_f32 v70, v32, v33
    v_lshlrev_b32 v32, 16, v71
    v_and_b32 v33, s3, v71
    v_pk_mul_f32 v[32:33], v[32:33], s[60:61]
    v_cvt_pk_bf16_f32 v71, v32, v33
    v_lshlrev_b32 v32, 16, v72
    v_and_b32 v33, s3, v72
    v_pk_mul_f32 v[32:33], v[32:33], s[60:61]
    v_cvt_pk_bf16_f32 v72, v32, v33
    v_lshlrev_b32 v32, 16, v73
    v_and_b32 v33, s3, v73
    v_pk_mul_f32 v[32:33], v[32:33], s[60:61]
    v_cvt_pk_bf16_f32 v73, v32, v33
    v_lshlrev_b32 v32, 16, v74
    v_and_b32 v33, s3, v74
    v_pk_mul_f32 v[32:33], v[32:33], s[60:61]
    v_cvt_pk_bf16_f32 v74, v32, v33
    v_lshlrev_b32 v32, 16, v75
    v_and_b32 v33, s3, v75
    v_pk_mul_f32 v[32:33], v[32:33], s[60:61]
    v_cvt_pk_bf16_f32 v75, v32, v33
    v_lshlrev_b32 v32, 16, v76
    v_and_b32 v33, s3, v76
    v_pk_mul_f32 v[32:33], v[32:33], s[60:61]
    v_cvt_pk_bf16_f32 v76, v32, v33
    v_lshlrev_b32 v32, 16, v77
    v_and_b32 v33, s3, v77
    v_pk_mul_f32 v[32:33], v[32:33], s[60:61]
    v_cvt_pk_bf16_f32 v77, v32, v33
    v_lshlrev_b32 v32, 16, v78
    v_and_b32 v33, s3, v78
    v_pk_mul_f32 v[32:33], v[32:33], s[60:61]
    v_cvt_pk_bf16_f32 v78, v32, v33
    v_lshlrev_b32 v32, 16, v79
    v_and_b32 v33, s3, v79
    v_pk_mul_f32 v[32:33], v[32:33], s[60:61]
    v_cvt_pk_bf16_f32 v79, v32, v33
    v_lshlrev_b32 v32, 16, v80
    v_and_b32 v33, s3, v80
    v_pk_mul_f32 v[32:33], v[32:33], s[60:61]
    v_cvt_pk_bf16_f32 v80, v32, v33
    v_lshlrev_b32 v32, 16, v81
    v_and_b32 v33, s3, v81
    v_pk_mul_f32 v[32:33], v[32:33], s[60:61]
    v_cvt_pk_bf16_f32 v81, v32, v33
    v_lshlrev_b32 v32, 16, v82
    v_and_b32 v33, s3, v82
    v_pk_mul_f32 v[32:33], v[32:33], s[60:61]
    v_cvt_pk_bf16_f32 v82, v32, v33
    v_lshlrev_b32 v32, 16, v83
    v_and_b32 v33, s3, v83
    v_pk_mul_f32 v[32:33], v[32:33], s[60:61]
    v_cvt_pk_bf16_f32 v83, v32, v33
    v_lshlrev_b32 v32, 16, v84
    v_and_b32 v33, s3, v84
    v_pk_mul_f32 v[32:33], v[32:33], s[60:61]
    v_cvt_pk_bf16_f32 v84, v32, v33
    v_lshlrev_b32 v32, 16, v85
    v_and_b32 v33, s3, v85
    v_pk_mul_f32 v[32:33], v[32:33], s[60:61]
    v_cvt_pk_bf16_f32 v85, v32, v33
    v_lshlrev_b32 v32, 16, v86
    v_and_b32 v33, s3, v86
    v_pk_mul_f32 v[32:33], v[32:33], s[60:61]
    v_cvt_pk_bf16_f32 v86, v32, v33
    v_lshlrev_b32 v32, 16, v87
    v_and_b32 v33, s3, v87
    v_pk_mul_f32 v[32:33], v[32:33], s[60:61]
    v_cvt_pk_bf16_f32 v87, v32, v33
    v_lshlrev_b32 v32, 16, v88
    v_and_b32 v33, s3, v88
    v_pk_mul_f32 v[32:33], v[32:33], s[60:61]
    v_cvt_pk_bf16_f32 v88, v32, v33
    v_lshlrev_b32 v32, 16, v89
    v_and_b32 v33, s3, v89
    v_pk_mul_f32 v[32:33], v[32:33], s[60:61]
    v_cvt_pk_bf16_f32 v89, v32, v33
    v_lshlrev_b32 v32, 16, v90
    v_and_b32 v33, s3, v90
    v_pk_mul_f32 v[32:33], v[32:33], s[60:61]
    v_cvt_pk_bf16_f32 v90, v32, v33
    v_lshlrev_b32 v32, 16, v91
    v_and_b32 v33, s3, v91
    v_pk_mul_f32 v[32:33], v[32:33], s[60:61]
    v_cvt_pk_bf16_f32 v91, v32, v33
    v_lshlrev_b32 v32, 16, v92
    v_and_b32 v33, s3, v92
    v_pk_mul_f32 v[32:33], v[32:33], s[60:61]
    v_cvt_pk_bf16_f32 v92, v32, v33
    v_lshlrev_b32 v32, 16, v93
    v_and_b32 v33, s3, v93
    v_pk_mul_f32 v[32:33], v[32:33], s[60:61]
    v_cvt_pk_bf16_f32 v93, v32, v33
    v_lshlrev_b32 v32, 16, v94
    v_and_b32 v33, s3, v94
    v_pk_mul_f32 v[32:33], v[32:33], s[60:61]
    v_cvt_pk_bf16_f32 v94, v32, v33
    v_lshlrev_b32 v32, 16, v95
    v_and_b32 v33, s3, v95
    v_pk_mul_f32 v[32:33], v[32:33], s[60:61]
    v_cvt_pk_bf16_f32 v95, v32, v33
    v_lshlrev_b32 v32, 16, v96
    v_and_b32 v33, s3, v96
    v_pk_mul_f32 v[32:33], v[32:33], s[60:61]
    v_cvt_pk_bf16_f32 v96, v32, v33
    v_lshlrev_b32 v32, 16, v97
    v_and_b32 v33, s3, v97
    v_pk_mul_f32 v[32:33], v[32:33], s[60:61]
    v_cvt_pk_bf16_f32 v97, v32, v33
    v_lshlrev_b32 v32, 16, v98
    v_and_b32 v33, s3, v98
    v_pk_mul_f32 v[32:33], v[32:33], s[60:61]
    v_cvt_pk_bf16_f32 v98, v32, v33
    v_lshlrev_b32 v32, 16, v99
    v_and_b32 v33, s3, v99
    v_pk_mul_f32 v[32:33], v[32:33], s[60:61]
    v_cvt_pk_bf16_f32 v99, v32, v33
    v_lshlrev_b32 v32, 16, v100
    v_and_b32 v33, s3, v100
    v_pk_mul_f32 v[32:33], v[32:33], s[60:61]
    v_cvt_pk_bf16_f32 v100, v32, v33
    v_lshlrev_b32 v32, 16, v101
    v_and_b32 v33, s3, v101
    v_pk_mul_f32 v[32:33], v[32:33], s[60:61]
    v_cvt_pk_bf16_f32 v101, v32, v33
    v_lshlrev_b32 v32, 16, v102
    v_and_b32 v33, s3, v102
    v_pk_mul_f32 v[32:33], v[32:33], s[60:61]
    v_cvt_pk_bf16_f32 v102, v32, v33
    v_lshlrev_b32 v32, 16, v103
    v_and_b32 v33, s3, v103
    v_pk_mul_f32 v[32:33], v[32:33], s[60:61]
    v_cvt_pk_bf16_f32 v103, v32, v33
L_retab:
    v_lshrrev_b32 v5, 4, v0
    v_lshlrev_b32 v6, 11, v5
    v_and_b32 v2, 15, v1
    v_lshlrev_b32 v2, 1, v2
    s_movk_i32 s3, 3200
    v_mul_u32_u24 v5, s3, v5
    s_mov_b32 s39, 0x40000
    s_not_b32 s3, s10
    s_mov_b32 s49, 0
    v_mov_b32 v153, s3
    v_mov_b32 v155, s3
    v_mov_b32 v157, s3
    v_mov_b32 v159, s3
    v_mov_b32 v161, s3
    v_mov_b32 v163, s3
    v_mov_b32 v165, s3
    v_mov_b32 v167, s3
L_tp:
    s_lshl_b32 s14, s13, 3
    v_cmpx_ne_u32 vcc, s10, v153
    buffer_load_dwordx2 v[152:153], v6, s[28:31], s14 offen sc1
    s_mov_b64 exec, -1
    s_add_u32 s14, s14, 0x10000
    v_cmpx_ne_u32 vcc, s10, v155
    buffer_load_dwordx2 v[154:155], v6, s[28:31], s14 offen sc1
    s_mov_b64 exec, -1
    s_add_u32 s14, s14, 0x10000
    v_cmpx_ne_u32 vcc, s10, v157
    buffer_load_dwordx2 v[156:157], v6, s[28:31], s14 offen sc1
    s_mov_b64 exec, -1
    s_add_u32 s14, s14, 0x10000
    v_cmpx_ne_u32 vcc, s10, v159
    buffer_load_dwordx2 v[158:159], v6, s[28:31], s14 offen sc1
    s_mov_b64 exec, -1
    s_add_u32 s14, s14, 0x10000
    v_cmpx_ne_u32 vcc, s10, v161
    buffer_load_dwordx2 v[160:161], v6, s[28:31], s14 offen sc1
    s_mov_b64 exec, -1
    s_add_u32 s14, s14, 0x10000
    v_cmpx_ne_u32 vcc, s10, v163
    buffer_load_dwordx2 v[162:163], v6, s[28:31], s14 offen sc1
    s_mov_b64 exec, -1
    s_add_u32 s14, s14, 0x10000
    v_cmpx_ne_u32 vcc, s10, v165
    buffer_load_dwordx2 v[164:165], v6, s[28:31], s14 offen sc1
    s_mov_b64 exec, -1
    s_add_u32 s14, s14, 0x10000
    v_cmpx_ne_u32 vcc, s10, v167
    buffer_load_dwordx2 v[166:167], v6, s[28:31], s14 offen sc1
    s_mov_b64 exec, -1
    s_waitcnt vmcnt(0)
    v_xor_b32 v252, s10, v153
    v_xor_b32 v253, s10, v155
    v_or_b32 v252, v252, v253
    v_xor_b32 v253, s10, v157
    v_or_b32 v252, v252, v253
    v_xor_b32 v253, s10, v159
    v_or_b32 v252, v252, v253
    v_xor_b32 v253, s10, v161
    v_or_b32 v252, v252, v253
    v_xor_b32 v253, s10, v163
    v_or_b32 v252, v252, v253
    v_xor_b32 v253, s10, v165
    v_or_b32 v252, v252, v253
    v_xor_b32 v253, s10, v167
    v_or_b32 v252, v252, v253
    v_cmp_ne_u32 vcc, 0, v252
    s_cbranch_vccz L_tp_ok
    s_sleep 4
    s_sub_u32 s39, s39, 1
    s_cmp_lg_u32 s39, 0
    s_cbranch_scc1 L_tp
    s_endpgm
L_tp_ok:
    v_mov_b32 v8, v152
    v_mov_b32 v9, v154
    v_mov_b32 v10, v156
    v_mov_b32 v11, v158
    v_mov_b32 v12, v160
    v_mov_b32 v13, v162
    v_mov_b32 v14, v164
    v_mov_b32 v15, v166
    v_max3_u32 v252, v8, v9, v10
    v_max3_u32 v252, v252, v11, v12
    v_max3_u32 v252, v252, v13, v14
    v_max_u32 v252, v252, v15
    v_lshrrev_b32 v6, 16, v252
    v_mov_b32 v253, 162560
    ds_max_u32 v253, v6
L_round:
    v_add_u32 v252, s50, v2
    s_add_u32 s54, s50, s51
    v_add_u32 v253, v252, v5
    s_mov_b32 s55, 0
    v_mov_b32 v255, 0x7f000000
    v_lshrrev_b32 v232, 16, v8
    v_min_u32 v232, s54, v232
    v_sub_u32 v232, v232, v252
    v_cmp_lt_i32 vcc, 0, v232
    v_and_b32 v254, 0xffff, v8
    v_add_lshl_u32 v254, v254, v253, 3
    v_cndmask_b32 v254, v255, v254, vcc
    buffer_load_dwordx4 v[152:155], v254, s[24:27], s55 offen sc1
    s_add_u32 s55, s55, 819200
    v_lshrrev_b32 v233, 16, v9
    v_min_u32 v233, s54, v233
    v_sub_u32 v233, v233, v252
    v_cmp_lt_i32 vcc, 0, v233
    v_and_b32 v254, 0xffff, v9
    v_add_lshl_u32 v254, v254, v253, 3
    v_cndmask_b32 v254, v255, v254, vcc
    buffer_load_dwordx4 v[156:159], v254, s[24:27], s55 offen sc1
    s_add_u32 s55, s55, 819200
    v_lshrrev_b32 v234, 16, v10
    v_min_u32 v234, s54, v234
    v_sub_u32 v234, v234, v252
    v_cmp_lt_i32 vcc, 0, v234
    v_and_b32 v254, 0xffff, v10
    v_add_lshl_u32 v254, v254, v253, 3
    v_cndmask_b32 v254, v255, v254, vcc
    buffer_load_dwordx4 v[160:163], v254, s[24:27], s55 offen sc1
    s_add_u32 s55, s55, 819200
    v_lshrrev_b32 v235, 16, v11
    v_min_u32 v235, s54, v235
    v_sub_u32 v235, v235, v252
    v_cmp_lt_i32 vcc, 0, v235
    v_and_b32 v254, 0xffff, v11
    v_add_lshl_u32 v254, v254, v253, 3
    v_cndmask_b32 v254, v255, v254, vcc
    buffer_load_dwordx4 v[164:167], v254, s[24:27], s55 offen sc1
    s_add_u32 s55, s55, 819200
    v_lshrrev_b32 v236, 16, v12
    v_min_u32 v236, s54, v236
    v_sub_u32 v236, v236, v252
    v_cmp_lt_i32 vcc, 0, v236
    v_and_b32 v254, 0xffff, v12
    v_add_lshl_u32 v254, v254, v253, 3
    v_cndmask_b32 v254, v255, v254, vcc
    buffer_load_dwordx4 v[168:171], v254, s[24:27], s55 offen sc1
    s_add_u32 s55, s55, 819200
    v_lshrrev_b32 v237, 16, v13
    v_min_u32 v237, s54, v237
    v_sub_u32 v237, v237, v252
    v_cmp_lt_i32 vcc, 0, v237
    v_and_b32 v254, 0xffff, v13
    v_add_lshl_u32 v254, v254, v253, 3
    v_cndmask_b32 v254, v255, v254, vcc
    buffer_load_dwordx4 v[172:175], v254, s[24:27], s55 offen sc1
    s_add_u32 s55, s55, 819200
    v_lshrrev_b32 v238, 16, v14
    v_min_u32 v238, s54, v238
    v_sub_u32 v238, v238, v252
    v_cmp_lt_i32 vcc, 0, v238
    v_and_b32 v254, 0xffff, v14
    v_add_lshl_u32 v254, v254, v253, 3
    v_cndmask_b32 v254, v255, v254, vcc
    buffer_load_dwordx4 v[176:179], v254, s[24:27], s55 offen sc1
    s_add_u32 s55, s55, 819200
    v_lshrrev_b32 v239, 16, v15
    v_min_u32 v239, s54, v239
    v_sub_u32 v239, v239, v252
    v_cmp_lt_i32 vcc, 0, v239
    v_and_b32 v254, 0xffff, v15
    v_add_lshl_u32 v254, v254, v253, 3
    v_cndmask_b32 v254, v255, v254, vcc
    buffer_load_dwordx4 v[180:183], v254, s[24:27], s55 offen sc1
    s_mov_b32 s18, 0x61a800
    v_add_u32 v253, v7, v22
    buffer_load_dwordx4 v[48:51], v253, s[16:19], s36 offen offset:0
    buffer_load_dwordx4 v[52:55], v253, s[16:19], s36 offen offset:32
    buffer_load_dwordx4 v[56:59], v253, s[16:19], s36 offen offset:64
    buffer_load_dwordx4 v[60:63], v253, s[16:19], s36 offen offset:96
    v_mov_b32 v252, 1
    s_mov_b32 s56, 162528
    s_movk_i32 s57, 512
    s_waitcnt vmcnt(8)
    v_and_b32 v200, 28, v152
    v_and_b32 v201, 28, v154
    v_add_u32 v253, s56, v200
    v_add_u32 v254, s56, v201
    v_cmpx_lt_i32 vcc, 0, v232
    ds_add_rtn_u32 v184, v253, v252
    v_cmpx_lt_i32 vcc, 1, v232
    ds_add_rtn_u32 v185, v254, v252
    s_mov_b64 exec, -1
    v_and_b32 v202, 28, v156
    v_and_b32 v203, 28, v158
    v_add_u32 v253, s56, v202
    v_add_u32 v254, s56, v203
    v_cmpx_lt_i32 vcc, 0, v233
    ds_add_rtn_u32 v186, v253, v252
    v_cmpx_lt_i32 vcc, 1, v233
    ds_add_rtn_u32 v187, v254, v252
    s_mov_b64 exec, -1
    v_and_b32 v204, 28, v160
    v_and_b32 v205, 28, v162
    v_add_u32 v253, s56, v204
    v_add_u32 v254, s56, v205
    v_cmpx_lt_i32 vcc, 0, v234
    ds_add_rtn_u32 v188, v253, v252
    v_cmpx_lt_i32 vcc, 1, v234
    ds_add_rtn_u32 v189, v254, v252
    s_mov_b64 exec, -1
    v_and_b32 v206, 28, v164
    v_and_b32 v207, 28, v166
    v_add_u32 v253, s56, v206
    v_add_u32 v254, s56, v207
    v_cmpx_lt_i32 vcc, 0, v235
    ds_add_rtn_u32 v190, v253, v252
    v_cmpx_lt_i32 vcc, 1, v235
    ds_add_rtn_u32 v191, v254, v252
    s_mov_b64 exec, -1
    s_mov_b32 s58, 98304
    v_lshlrev_b32 v200, 9, v200
    v_add_u32 v200, s58, v200
    v_lshlrev_b32 v201, 9, v201
    v_add_u32 v201, s58, v201
    v_lshlrev_b32 v202, 9, v202
    v_add_u32 v202, s58, v202
    v_lshlrev_b32 v203, 9, v203
    v_add_u32 v203, s58, v203
    v_lshlrev_b32 v204, 9, v204
    v_add_u32 v204, s58, v204
    v_lshlrev_b32 v205, 9, v205
    v_add_u32 v205, s58, v205
    v_lshlrev_b32 v206, 9, v206
    v_add_u32 v206, s58, v206
    v_lshlrev_b32 v207, 9, v207
    v_add_u32 v207, s58, v207
    s_waitcnt lgkmcnt(0)
    v_lshl_add_u32 v200, v184, 2, v200
    v_cmpx_lt_i32 vcc, 0, v232
    v_cmpx_gt_u32 vcc, s57, v184
    ds_write2st64_b32 v200, v152, v153 offset0:0 offset1:64
    s_mov_b64 exec, -1
    v_lshl_add_u32 v201, v185, 2, v201
    v_cmpx_lt_i32 vcc, 1, v232
    v_cmpx_gt_u32 vcc, s57, v185
    ds_write2st64_b32 v201, v154, v155 offset0:0 offset1:64
    s_mov_b64 exec, -1
    v_lshl_add_u32 v202, v186, 2, v202
    v_cmpx_lt_i32 vcc, 0, v233
    v_cmpx_gt_u32 vcc, s57, v186
    ds_write2st64_b32 v202, v156, v157 offset0:0 offset1:64
    s_mov_b64 exec, -1
    v_lshl_add_u32 v203, v187, 2, v203
    v_cmpx_lt_i32 vcc, 1, v233
    v_cmpx_gt_u32 vcc, s57, v187
    ds_write2st64_b32 v203, v158, v159 offset0:0 offset1:64
    s_mov_b64 exec, -1
    v_lshl_add_u32 v204, v188, 2, v204
    v_cmpx_lt_i32 vcc, 0, v234
    v_cmpx_gt_u32 vcc, s57, v188
    ds_write2st64_b32 v204, v160, v161 offset0:0 offset1:64
    s_mov_b64 exec, -1
    v_lshl_add_u32 v205, v189, 2, v205
    v_cmpx_lt_i32 vcc, 1, v234
    v_cmpx_gt_u32 vcc, s57, v189
    ds_write2st64_b32 v205, v162, v163 offset0:0 offset1:64
    s_mov_b64 exec, -1
    v_lshl_add_u32 v206, v190, 2, v206
    v_cmpx_lt_i32 vcc, 0, v235
    v_cmpx_gt_u32 vcc, s57, v190
    ds_write2st64_b32 v206, v164, v165 offset0:0 offset1:64
    s_mov_b64 exec, -1
    v_lshl_add_u32 v207, v191, 2, v207
    v_cmpx_lt_i32 vcc, 1, v235
    v_cmpx_gt_u32 vcc, s57, v191
    ds_write2st64_b32 v207, v166, v167 offset0:0 offset1:64
    s_mov_b64 exec, -1
    s_waitcnt vmcnt(4)
    s_cmp_lg_u32 s52, 1
    s_cbranch_scc1 L_noearly
    s_mov_b32 s52, 2
    s_lshl_b32 s46, s12, 11
    v_lshrrev_b32 v23, 3, v1
    v_lshlrev_b32 v23, 4, v23
    v_add_u32 v23, s46, v23
    v_add_u32 v23, 98304, v23
    v_and_b32 v24, 7, v3
    v_lshrrev_b32 v254, 3, v3
    v_lshl_add_u32 v24, v24, 2, v254
    v_lshlrev_b32 v24, 2, v24
    v_add_u32 v24, s46, v24
    v_add_u32 v24, 114688, v24
    s_lshl_b32 s3, s12, 2
    s_add_u32 s3, s3, s56
    v_mov_b32 v253, s3
    s_waitcnt lgkmcnt(0)
    s_barrier
    ds_read_b32 v253, v253
    ds_read_b128 v[248:251], v23
    ds_read_b32 v244, v24
    s_waitcnt lgkmcnt(0)
    s_barrier
    v_readfirstlane_b32 s48, v253
    s_cmp_lt_u32 s48, 32
    s_cbranch_scc1 L_noearly
    s_cmp_lt_u32 s49, s48
    s_cselect_b32 s18, 0x61a800, 0
    s_cselect_b32 s22, 0x186a000, 0
    s_add_u32 s49, s49, 1
    s_add_u32 m0, s41, 0
    v_and_or_b32 v248, v248, s64, v20
    buffer_load_dwordx4 v248, s[16:19], 0 offen lds
    s_add_u32 m0, s41, 1024
    v_and_or_b32 v249, v249, s64, v21
    buffer_load_dwordx4 v249, s[16:19], 0 offen lds
    s_add_u32 m0, s41, 2048
    v_and_or_b32 v250, v250, s64, v20
    buffer_load_dwordx4 v250, s[16:19], 0 offen lds
    s_add_u32 m0, s41, 3072
    v_and_or_b32 v251, v251, s64, v21
    buffer_load_dwordx4 v251, s[16:19], 0 offen lds
    v_and_or_b32 v252, v244, s65, v22
    buffer_load_dwordx4 v[216:219], v252, s[20:23], 0 offen nt
    v_mov_b32 v252, 1
L_noearly:
    v_and_b32 v208, 28, v168
    v_and_b32 v209, 28, v170
    v_add_u32 v253, s56, v208
    v_add_u32 v254, s56, v209
    v_cmpx_lt_i32 vcc, 0, v236
    ds_add_rtn_u32 v192, v253, v252
    v_cmpx_lt_i32 vcc, 1, v236
    ds_add_rtn_u32 v193, v254, v252
    s_mov_b64 exec, -1
    v_and_b32 v210, 28, v172
    v_and_b32 v211, 28, v174
    v_add_u32 v253, s56, v210
    v_add_u32 v254, s56, v211
    v_cmpx_lt_i32 vcc, 0, v237
    ds_add_rtn_u32 v194, v253, v252
    v_cmpx_lt_i32 vcc, 1, v237
    ds_add_rtn_u32 v195, v254, v252
    s_mov_b64 exec, -1
    v_and_b32 v212, 28, v176
    v_and_b32 v213, 28, v178
    v_add_u32 v253, s56, v212
    v_add_u32 v254, s56, v213
    v_cmpx_lt_i32 vcc, 0, v238
    ds_add_rtn_u32 v196, v253, v252
    v_cmpx_lt_i32 vcc, 1, v238
    ds_add_rtn_u32 v197, v254, v252
    s_mov_b64 exec, -1
    v_and_b32 v214, 28, v180
    v_and_b32 v215, 28, v182
    v_add_u32 v253, s56, v214
    v_add_u32 v254, s56, v215
    v_cmpx_lt_i32 vcc, 0, v239
    ds_add_rtn_u32 v198, v253, v252
    v_cmpx_lt_i32 vcc, 1, v239
    ds_add_rtn_u32 v199, v254, v252
    s_mov_b64 exec, -1
    s_mov_b32 s58, 98304
    v_lshlrev_b32 v208, 9, v208
    v_add_u32 v208, s58, v208
    v_lshlrev_b32 v209, 9, v209
    v_add_u32 v209, s58, v209
    v_lshlrev_b32 v210, 9, v210
    v_add_u32 v210, s58, v210
    v_lshlrev_b32 v211, 9, v211
    v_add_u32 v211, s58, v211
    v_lshlrev_b32 v212, 9, v212
    v_add_u32 v212, s58, v212
    v_lshlrev_b32 v213, 9, v213
    v_add_u32 v213, s58, v213
    v_lshlrev_b32 v214, 9, v214
    v_add_u32 v214, s58, v214
    v_lshlrev_b32 v215, 9, v215
    v_add_u32 v215, s58, v215
    s_waitcnt lgkmcnt(0)
    v_lshl_add_u32 v208, v192, 2, v208
    v_cmpx_lt_i32 vcc, 0, v236
    v_cmpx_gt_u32 vcc, s57, v192
    ds_write2st64_b32 v208, v168, v169 offset0:0 offset1:64
    s_mov_b64 exec, -1
    v_lshl_add_u32 v209, v193, 2, v209
    v_cmpx_lt_i32 vcc, 1, v236
    v_cmpx_gt_u32 vcc, s57, v193
    ds_write2st64_b32 v209, v170, v171 offset0:0 offset1:64
    s_mov_b64 exec, -1
    v_lshl_add_u32 v210, v194, 2, v210
    v_cmpx_lt_i32 vcc, 0, v237
    v_cmpx_gt_u32 vcc, s57, v194
    ds_write2st64_b32 v210, v172, v173 offset0:0 offset1:64
    s_mov_b64 exec, -1
    v_lshl_add_u32 v211, v195, 2, v211
    v_cmpx_lt_i32 vcc, 1, v237
    v_cmpx_gt_u32 vcc, s57, v195
    ds_write2st64_b32 v211, v174, v175 offset0:0 offset1:64
    s_mov_b64 exec, -1
    v_lshl_add_u32 v212, v196, 2, v212
    v_cmpx_lt_i32 vcc, 0, v238
    v_cmpx_gt_u32 vcc, s57, v196
    ds_write2st64_b32 v212, v176, v177 offset0:0 offset1:64
    s_mov_b64 exec, -1
    v_lshl_add_u32 v213, v197, 2, v213
    v_cmpx_lt_i32 vcc, 1, v238
    v_cmpx_gt_u32 vcc, s57, v197
    ds_write2st64_b32 v213, v178, v179 offset0:0 offset1:64
    s_mov_b64 exec, -1
    v_lshl_add_u32 v214, v198, 2, v214
    v_cmpx_lt_i32 vcc, 0, v239
    v_cmpx_gt_u32 vcc, s57, v198
    ds_write2st64_b32 v214, v180, v181 offset0:0 offset1:64
    s_mov_b64 exec, -1
    v_lshl_add_u32 v215, v199, 2, v215
    v_cmpx_lt_i32 vcc, 1, v239
    v_cmpx_gt_u32 vcc, s57, v199
    ds_write2st64_b32 v215, v182, v183 offset0:0 offset1:64
    s_mov_b64 exec, -1
    s_cmp_lg_u32 s53, 0
    s_cbranch_scc1 L2_ins_done
    s_add_u32 s50, s50, 32
    v_cmp_lt_u32 vcc, s50, v6
    s_cbranch_vccnz L_round
L2_ins_done:
    s_waitcnt lgkmcnt(0)
    s_barrier
    v_and_b32 v252, 15, v1
    v_lshlrev_b32 v252, 2, v252
    v_add_u32 v252, s56, v252
    ds_read_b32 v253, v252
    s_lshl_b32 s46, s12, 11
    v_lshrrev_b32 v23, 3, v1
    v_lshlrev_b32 v23, 4, v23
    v_add_u32 v23, s46, v23
    v_add_u32 v23, 98304, v23
    v_and_b32 v24, 7, v3
    v_lshrrev_b32 v254, 3, v3
    v_lshl_add_u32 v24, v24, 2, v254
    v_lshlrev_b32 v24, 2, v24
    v_add_u32 v24, s46, v24
    v_add_u32 v24, 114688, v24
    s_waitcnt lgkmcnt(0)
    v_readlane_b32 s47, v253, s12
    v_readlane_b32 s59, v253, 8
    s_cmp_lg_u32 s53, 0
    s_cbranch_scc1 L2_go
    v_cmp_lt_u32 vcc, s57, v253
    s_and_b32 vcc_lo, vcc_lo, 0xff
    s_cbranch_scc0 L2_go
    s_barrier
    s_mov_b32 s53, 1
    s_mov_b32 s51, 2
    s_mov_b32 s50, 0
    s_lshl_b32 s3, s12, 2
    s_add_u32 s3, s3, s56
    v_mov_b32 v252, s3
    ds_write_b32 v252, v29
    s_mov_b32 s49, 0
    s_waitcnt vmcnt(0) lgkmcnt(0)
    s_barrier
    s_branch L_round
L2_go:
    s_cmp_lt_u32 s12, 4
    s_cselect_b32 s67, 3, -1
    s_setprio 1
    s_add_u32 s48, s47, 31
    s_lshr_b32 s48, s48, 5
    v_add_u32 v252, s47, v1
    s_lshl_b32 s3, s48, 5
    v_mov_b32 v253, 0x7f000000
    v_mov_b32 v254, 0x7f000019
    v_cmpx_gt_u32 vcc, s3, v252
    v_lshlrev_b32 v252, 2, v252
    v_add_u32 v252, s46, v252
    v_add_u32 v252, 98304, v252
    ds_write2st64_b32 v252, v253, v254 offset0:0 offset1:64
    s_mov_b64 exec, -1
    ds_read_b128 v[184:187], v23 offset:0
    ds_read_b32 v200, v24 offset:0
    ds_read_b128 v[188:191], v23 offset:128
    ds_read_b32 v201, v24 offset:128
    ds_read_b128 v[192:195], v23 offset:256
    ds_read_b32 v202, v24 offset:256
    ds_read_b128 v[196:199], v23 offset:384
    ds_read_b32 v245, v24
    s_waitcnt lgkmcnt(0)
    s_cmp_lg_u32 s49, 0
    s_cbranch_scc1 L_t0done
    v_mov_b32 v248, v184
    v_mov_b32 v249, v185
    v_mov_b32 v250, v186
    v_mov_b32 v251, v187
    v_mov_b32 v244, v200
    s_cmp_lt_u32 s49, s48
    s_cselect_b32 s18, 0x61a800, 0
    s_cselect_b32 s22, 0x186a000, 0
    s_add_u32 s49, s49, 1
    s_add_u32 m0, s41, 0
    v_and_or_b32 v248, v248, s64, v20
    buffer_load_dwordx4 v248, s[16:19], 0 offen lds
    s_add_u32 m0, s41, 1024
    v_and_or_b32 v249, v249, s64, v21
    buffer_load_dwordx4 v249, s[16:19], 0 offen lds
    s_add_u32 m0, s41, 2048
    v_and_or_b32 v250, v250, s64, v20
    buffer_load_dwordx4 v250, s[16:19], 0 offen lds
    s_add_u32 m0, s41, 3072
    v_and_or_b32 v251, v251, s64, v21
    buffer_load_dwordx4 v251, s[16:19], 0 offen lds
    v_and_or_b32 v252, v244, s65, v22
    buffer_load_dwordx4 v[216:219], v252, s[20:23], 0 offen nt
L_t0done:
    v_mov_b32 v248, v188
    v_mov_b32 v249, v189
    v_mov_b32 v250, v190
    v_mov_b32 v251, v191
    v_mov_b32 v244, v201
    s_cmp_lt_u32 s49, s48
    s_cselect_b32 s18, 0x61a800, 0
    s_cselect_b32 s22, 0x186a000, 0
    s_add_u32 s49, s49, 1
    s_add_u32 m0, s41, 4096
    v_and_or_b32 v248, v248, s64, v20
    buffer_load_dwordx4 v248, s[16:19], 0 offen lds
    s_add_u32 m0, s41, 5120
    v_and_or_b32 v249, v249, s64, v21
    buffer_load_dwordx4 v249, s[16:19], 0 offen lds
    s_add_u32 m0, s41, 6144
    v_and_or_b32 v250, v250, s64, v20
    buffer_load_dwordx4 v250, s[16:19], 0 offen lds
    s_add_u32 m0, s41, 7168
    v_and_or_b32 v251, v251, s64, v21
    buffer_load_dwordx4 v251, s[16:19], 0 offen lds
    v_and_or_b32 v252, v244, s65, v22
    buffer_load_dwordx4 v[220:223], v252, s[20:23], 0 offen nt
    s_cmp_eq_u32 s52, 0
    s_cbranch_scc1 L_nosetup
    s_mov_b32 s52, 0
    s_waitcnt vmcnt(10)
    v_mfma_f32_32x32x16_bf16 v[152:167], v[48:51], v[120:123], 0
    v_mfma_f32_32x32x16_bf16 v[152:167], v[52:55], v[128:131], v[152:167]
    v_mfma_f32_32x32x16_bf16 v[152:167], v[56:59], v[136:139], v[152:167]
    v_mfma_f32_32x32x16_bf16 v[152:167], v[60:63], v[144:147], v[152:167]
    v_mfma_f32_32x32x16_bf16 v[168:183], v[48:51], v[124:127], 0
    v_mfma_f32_32x32x16_bf16 v[168:183], v[52:55], v[132:135], v[168:183]
    v_mfma_f32_32x32x16_bf16 v[168:183], v[56:59], v[140:143], v[168:183]
    v_mfma_f32_32x32x16_bf16 v[168:183], v[60:63], v[148:151], v[168:183]
    v_mov_b32 v120, 0
    v_mov_b32 v121, 0
    v_mov_b32 v122, 0
    v_mov_b32 v123, 0
    v_mov_b32 v124, 0
    v_mov_b32 v125, 0
    v_mov_b32 v126, 0
    v_mov_b32 v127, 0
    v_mov_b32 v128, 0
    v_mov_b32 v129, 0
    v_mov_b32 v130, 0
    v_mov_b32 v131, 0
    v_mov_b32 v132, 0
    v_mov_b32 v133, 0
    v_mov_b32 v134, 0
    v_mov_b32 v135, 0
    v_mov_b32 v136, 0
    v_mov_b32 v137, 0
    v_mov_b32 v138, 0
    v_mov_b32 v139, 0
    v_mov_b32 v140, 0
    v_mov_b32 v141, 0
    v_mov_b32 v142, 0
    v_mov_b32 v143, 0
    v_mov_b32 v144, 0
    v_mov_b32 v145, 0
    v_mov_b32 v146, 0
    v_mov_b32 v147, 0
    v_mov_b32 v148, 0
    v_mov_b32 v149, 0
    v_mov_b32 v150, 0
    v_mov_b32 v151, 0
    v_pk_mul_f32 v[152:153], v[152:153], s[60:61]
    v_pk_mul_f32 v[154:155], v[154:155], s[60:61]
    v_pk_mul_f32 v[156:157], v[156:157], s[60:61]
    v_pk_mul_f32 v[158:159], v[158:159], s[60:61]
    v_pk_mul_f32 v[160:161], v[160:161], s[60:61]
    v_pk_mul_f32 v[162:163], v[162:163], s[60:61]
    v_pk_mul_f32 v[164:165], v[164:165], s[60:61]
    v_pk_mul_f32 v[166:167], v[166:167], s[60:61]
    v_pk_mul_f32 v[168:169], v[168:169], s[60:61]
    v_pk_mul_f32 v[170:171], v[170:171], s[60:61]
    v_pk_mul_f32 v[172:173], v[172:173], s[60:61]
    v_pk_mul_f32 v[174:175], v[174:175], s[60:61]
    v_pk_mul_f32 v[176:177], v[176:177], s[60:61]
    v_pk_mul_f32 v[178:179], v[178:179], s[60:61]
    v_pk_mul_f32 v[180:181], v[180:181], s[60:61]
    v_pk_mul_f32 v[182:183], v[182:183], s[60:61]
    v_cvt_pk_bf16_f32 v104, v152, v153
    v_cvt_pk_bf16_f32 v105, v154, v155
    v_cvt_pk_bf16_f32 v106, v156, v157
    v_cvt_pk_bf16_f32 v107, v158, v159
    v_cvt_pk_bf16_f32 v112, v160, v161
    v_cvt_pk_bf16_f32 v113, v162, v163
    v_cvt_pk_bf16_f32 v114, v164, v165
    v_cvt_pk_bf16_f32 v115, v166, v167
    v_cvt_pk_bf16_f32 v108, v168, v169
    v_cvt_pk_bf16_f32 v109, v170, v171
    v_cvt_pk_bf16_f32 v110, v172, v173
    v_cvt_pk_bf16_f32 v111, v174, v175
    v_cvt_pk_bf16_f32 v116, v176, v177
    v_cvt_pk_bf16_f32 v117, v178, v179
    v_cvt_pk_bf16_f32 v118, v180, v181
    v_cvt_pk_bf16_f32 v119, v182, v183
L_nosetup:
    s_barrier
    v_mov_b32 v248, v192
    v_mov_b32 v249, v193
    v_mov_b32 v250, v194
    v_mov_b32 v251, v195
    v_mov_b32 v244, v202
    s_cmp_lt_u32 s49, s48
    s_cselect_b32 s18, 0x61a800, 0
    s_cselect_b32 s22, 0x186a000, 0
    s_add_u32 s49, s49, 1
    s_add_u32 m0, s41, 8192
    v_and_or_b32 v248, v248, s64, v20
    buffer_load_dwordx4 v248, s[16:19], 0 offen lds
    s_add_u32 m0, s41, 9216
    v_and_or_b32 v249, v249, s64, v21
    buffer_load_dwordx4 v249, s[16:19], 0 offen lds
    s_add_u32 m0, s41, 10240
    v_and_or_b32 v250, v250, s64, v20
    buffer_load_dwordx4 v250, s[16:19], 0 offen lds
    s_add_u32 m0, s41, 11264
    v_and_or_b32 v251, v251, s64, v21
    buffer_load_dwordx4 v251, s[16:19], 0 offen lds
    v_and_or_b32 v252, v244, s65, v22
    buffer_load_dwordx4 v[224:227], v252, s[20:23], 0 offen nt
    v_mov_b32 v248, v196
    v_mov_b32 v249, v197
    v_mov_b32 v250, v198
    v_mov_b32 v251, v199
    v_and_b32 v253, 31, v245
    v_lshl_add_u32 v247, v253, 4, v25
    v_lshl_add_u32 v246, v253, 4, v26
    v_mov_b32 v236, 0
    v_mov_b32 v208, 0
    v_mov_b32 v237, 0
    v_mov_b32 v209, 0
    v_mov_b32 v238, 0
    v_mov_b32 v210, 0
    v_mov_b32 v239, 0
    v_mov_b32 v211, 0
    v_mov_b32 v240, 0
    v_mov_b32 v212, 0
    v_mov_b32 v241, 0
    v_mov_b32 v213, 0
    v_mov_b32 v242, 0
    v_mov_b32 v214, 0
    v_mov_b32 v243, 0
    v_mov_b32 v215, 0
    ds_read_b128 v[200:203], v247
    ds_read_b128 v[204:207], v247 offset:832
    ds_read_b32 v244, v24 offset:384
    ds_read_b32 v245, v24 offset:128
    v_add_u32 v23, 0x200, v23
    s_waitcnt vmcnt(10)
    ds_read_b128 v[184:187], v16
    ds_read_b128 v[188:191], v17
    ds_read_b128 v[192:195], v18
    ds_read_b128 v[196:199], v19
    v_mfma_f32_32x32x16_bf16 v[152:167], v[216:219], v[96:99], 0
    s_waitcnt lgkmcnt(0)
    v_mfma_f32_32x32x16_bf16 v[152:167], v[200:203], v[104:107], v[152:167]
    v_mfma_f32_32x32x16_bf16 v[152:167], v[204:207], v[112:115], v[152:167]
    v_mfma_f32_32x32x16_bf16 v[152:167], v[184:187], v[64:67], v[152:167]
    v_mfma_f32_32x32x16_bf16 v[152:167], v[188:191], v[72:75], v[152:167]
    v_mfma_f32_32x32x16_bf16 v[152:167], v[192:195], v[80:83], v[152:167]
    v_mfma_f32_32x32x16_bf16 v[152:167], v[196:199], v[88:91], v[152:167]
    s_cmp_lt_u32 s49, s48
    s_cselect_b32 s18, 0x61a800, 0
    s_cselect_b32 s22, 0x186a000, 0
    s_add_u32 s49, s49, 1
    s_add_u32 m0, s41, 0
    v_and_or_b32 v248, v248, s64, v20
    buffer_load_dwordx4 v248, s[16:19], 0 offen lds
    s_add_u32 m0, s41, 1024
    v_and_or_b32 v249, v249, s64, v21
    buffer_load_dwordx4 v249, s[16:19], 0 offen lds
    s_add_u32 m0, s41, 2048
    v_and_or_b32 v250, v250, s64, v20
    buffer_load_dwordx4 v250, s[16:19], 0 offen lds
    s_add_u32 m0, s41, 3072
    v_and_or_b32 v251, v251, s64, v21
    buffer_load_dwordx4 v251, s[16:19], 0 offen lds
    s_cmp_eq_u32 s48, 0
    s_cbranch_scc1 L2_loop_skip
    s_mov_b32 s66, s48
L2_loop:
    v_mfma_f32_32x32x16_bf16 v[136:151], v[236:239], v[208:211], v[136:151]
    ds_write_b16 v246, v28
    v_exp_f32 v32, v152
    v_exp_f32 v33, v153
    v_exp_f32 v34, v154
    v_mfma_f32_32x32x16_bf16 v[136:151], v[240:243], v[212:215], v[136:151]
    ds_read_b128 v[208:211], v27
    ds_read_b128 v[212:215], v27 offset:832
    ds_write_b16 v246, v29
    v_exp_f32 v35, v155
    v_exp_f32 v36, v156
    v_exp_f32 v37, v157
    v_mfma_f32_32x32x16_bf16 v[168:183], v[216:219], v[100:103], 0
    v_and_or_b32 v252, v244, s65, v22
    buffer_load_dwordx4 v[216:219], v252, s[20:23], 0 offen nt
    v_exp_f32 v38, v158
    v_exp_f32 v39, v159
    v_exp_f32 v40, v160
    v_mfma_f32_32x32x16_bf16 v[168:183], v[200:203], v[108:111], v[168:183]
    v_exp_f32 v41, v161
    v_exp_f32 v42, v162
    v_exp_f32 v43, v163
    v_mfma_f32_32x32x16_bf16 v[168:183], v[204:207], v[116:119], v[168:183]
    v_exp_f32 v44, v164
    v_exp_f32 v45, v165
    v_exp_f32 v46, v166
    v_exp_f32 v47, v167
    v_and_b32 v253, 31, v245
    v_lshl_add_u32 v247, v253, 4, v25
    v_lshl_add_u32 v246, v253, 4, v26
    ds_read_b128 v[200:203], v247
    ds_read_b128 v[204:207], v247 offset:832
    ds_read_b128 v[248:251], v23
    v_pk_add_f32 v[32:33], v[32:33], s[62:63]
    v_pk_add_f32 v[34:35], v[34:35], s[62:63]
    v_pk_add_f32 v[36:37], v[36:37], s[62:63]
    v_pk_add_f32 v[38:39], v[38:39], s[62:63]
    v_pk_add_f32 v[40:41], v[40:41], s[62:63]
    v_pk_add_f32 v[42:43], v[42:43], s[62:63]
    v_pk_add_f32 v[44:45], v[44:45], s[62:63]
    v_pk_add_f32 v[46:47], v[46:47], s[62:63]
    v_mfma_f32_32x32x16_bf16 v[168:183], v[184:187], v[68:71], v[168:183]
    s_waitcnt vmcnt(10)
    ds_read_b128 v[184:187], v16 offset:4096
    v_rcp_f32 v32, v32
    v_rcp_f32 v33, v33
    v_rcp_f32 v34, v34
    v_mfma_f32_32x32x16_bf16 v[168:183], v[188:191], v[76:79], v[168:183]
    ds_read_b128 v[188:191], v17 offset:4096
    v_rcp_f32 v35, v35
    v_rcp_f32 v36, v36
    v_rcp_f32 v37, v37
    v_mfma_f32_32x32x16_bf16 v[168:183], v[192:195], v[84:87], v[168:183]
    ds_read_b128 v[192:195], v18 offset:4096
    v_rcp_f32 v38, v38
    v_rcp_f32 v39, v39
    v_rcp_f32 v40, v40
    v_mfma_f32_32x32x16_bf16 v[168:183], v[196:199], v[92:95], v[168:183]
    ds_read_b128 v[196:199], v19 offset:4096
    v_rcp_f32 v41, v41
    v_rcp_f32 v42, v42
    v_rcp_f32 v43, v43
    v_rcp_f32 v44, v44
    v_rcp_f32 v45, v45
    v_rcp_f32 v46, v46
    v_rcp_f32 v47, v47
    v_add_u32 v23, 0x80, v23
    v_add_u32 v24, 0x80, v24
    v_pk_mul_f32 v[32:33], v[152:153], v[32:33]
    v_pk_mul_f32 v[34:35], v[154:155], v[34:35]
    v_pk_mul_f32 v[36:37], v[156:157], v[36:37]
    v_pk_mul_f32 v[38:39], v[158:159], v[38:39]
    v_pk_mul_f32 v[40:41], v[160:161], v[40:41]
    v_pk_mul_f32 v[42:43], v[162:163], v[42:43]
    v_pk_mul_f32 v[44:45], v[164:165], v[44:45]
    v_pk_mul_f32 v[46:47], v[166:167], v[46:47]
    v_cvt_pk_bf16_f32 v228, v32, v33
    v_cvt_pk_bf16_f32 v229, v34, v35
    v_cvt_pk_bf16_f32 v230, v36, v37
    v_cvt_pk_bf16_f32 v231, v38, v39
    v_cvt_pk_bf16_f32 v232, v40, v41
    v_cvt_pk_bf16_f32 v233, v42, v43
    v_cvt_pk_bf16_f32 v234, v44, v45
    v_cvt_pk_bf16_f32 v235, v46, v47
    s_waitcnt lgkmcnt(0)
    v_mfma_f32_32x32x16_bf16 v[152:167], v[220:223], v[96:99], 0
    ds_read_b32 v244, v24 offset:384
    ds_read_b32 v245, v24 offset:128
    s_cmp_lt_u32 s49, s48
    s_cselect_b32 s18, 0x61a800, 0
    s_cselect_b32 s22, 0x186a000, 0
    s_add_u32 s49, s49, 1
    v_exp_f32 v32, v168
    v_exp_f32 v33, v169
    v_exp_f32 v34, v170
    v_mfma_f32_32x32x16_bf16 v[152:167], v[200:203], v[104:107], v[152:167]
    s_add_u32 m0, s41, 4096
    v_and_or_b32 v248, v248, s64, v20
    buffer_load_dwordx4 v248, s[16:19], 0 offen lds
    v_exp_f32 v35, v171
    v_exp_f32 v36, v172
    v_exp_f32 v37, v173
    v_mfma_f32_32x32x16_bf16 v[152:167], v[204:207], v[112:115], v[152:167]
    s_add_u32 m0, s41, 5120
    v_and_or_b32 v249, v249, s64, v21
    buffer_load_dwordx4 v249, s[16:19], 0 offen lds
    v_exp_f32 v38, v174
    v_exp_f32 v39, v175
    v_exp_f32 v40, v176
    v_mfma_f32_32x32x16_bf16 v[152:167], v[184:187], v[64:67], v[152:167]
    s_add_u32 m0, s41, 6144
    v_and_or_b32 v250, v250, s64, v20
    buffer_load_dwordx4 v250, s[16:19], 0 offen lds
    v_exp_f32 v41, v177
    v_exp_f32 v42, v178
    v_exp_f32 v43, v179
    v_mfma_f32_32x32x16_bf16 v[152:167], v[188:191], v[72:75], v[152:167]
    s_add_u32 m0, s41, 7168
    v_and_or_b32 v251, v251, s64, v21
    buffer_load_dwordx4 v251, s[16:19], 0 offen lds
    v_exp_f32 v44, v180
    v_exp_f32 v45, v181
    v_exp_f32 v46, v182
    v_exp_f32 v47, v183
    v_pk_add_f32 v[32:33], v[32:33], s[62:63]
    v_pk_add_f32 v[34:35], v[34:35], s[62:63]
    v_pk_add_f32 v[36:37], v[36:37], s[62:63]
    v_pk_add_f32 v[38:39], v[38:39], s[62:63]
    v_pk_add_f32 v[40:41], v[40:41], s[62:63]
    v_pk_add_f32 v[42:43], v[42:43], s[62:63]
    v_pk_add_f32 v[44:45], v[44:45], s[62:63]
    v_pk_add_f32 v[46:47], v[46:47], s[62:63]
    v_mfma_f32_32x32x16_bf16 v[152:167], v[192:195], v[80:83], v[152:167]
    v_rcp_f32 v32, v32
    v_rcp_f32 v33, v33
    v_rcp_f32 v34, v34
    v_mfma_f32_32x32x16_bf16 v[152:167], v[196:199], v[88:91], v[152:167]
    v_rcp_f32 v35, v35
    v_rcp_f32 v36, v36
    v_rcp_f32 v37, v37
    v_mfma_f32_32x32x16_bf16 v[120:135], v[228:231], v[208:211], v[120:135]
    v_rcp_f32 v38, v38
    v_rcp_f32 v39, v39
    v_rcp_f32 v40, v40
    v_mfma_f32_32x32x16_bf16 v[120:135], v[232:235], v[212:215], v[120:135]
    v_rcp_f32 v41, v41
    v_rcp_f32 v42, v42
    v_rcp_f32 v43, v43
    v_rcp_f32 v44, v44
    v_rcp_f32 v45, v45
    v_rcp_f32 v46, v46
    v_rcp_f32 v47, v47
    s_waitcnt lgkmcnt(0)
    v_pk_mul_f32 v[32:33], v[168:169], v[32:33]
    v_pk_mul_f32 v[34:35], v[170:171], v[34:35]
    v_pk_mul_f32 v[36:37], v[172:173], v[36:37]
    v_pk_mul_f32 v[38:39], v[174:175], v[38:39]
    v_pk_mul_f32 v[40:41], v[176:177], v[40:41]
    v_pk_mul_f32 v[42:43], v[178:179], v[42:43]
    v_pk_mul_f32 v[44:45], v[180:181], v[44:45]
    v_pk_mul_f32 v[46:47], v[182:183], v[46:47]
    v_cvt_pk_bf16_f32 v236, v32, v33
    v_cvt_pk_bf16_f32 v237, v34, v35
    v_cvt_pk_bf16_f32 v238, v36, v37
    v_cvt_pk_bf16_f32 v239, v38, v39
    v_cvt_pk_bf16_f32 v240, v40, v41
    v_cvt_pk_bf16_f32 v241, v42, v43
    v_cvt_pk_bf16_f32 v242, v44, v45
    v_cvt_pk_bf16_f32 v243, v46, v47
    s_cmp_lg_u32 s66, s67
    s_cbranch_scc1 L_pk0
    s_setprio 0
L_pk0:
    s_sub_u32 s66, s66, 1
    s_cmp_eq_u32 s66, 0
    s_cbranch_scc1 L2_loop_done
    v_mfma_f32_32x32x16_bf16 v[136:151], v[236:239], v[208:211], v[136:151]
    ds_write_b16 v246, v28
    v_exp_f32 v32, v152
    v_exp_f32 v33, v153
    v_exp_f32 v34, v154
    v_mfma_f32_32x32x16_bf16 v[136:151], v[240:243], v[212:215], v[136:151]
    ds_read_b128 v[208:211], v27
    ds_read_b128 v[212:215], v27 offset:832
    ds_write_b16 v246, v29
    v_exp_f32 v35, v155
    v_exp_f32 v36, v156
    v_exp_f32 v37, v157
    v_mfma_f32_32x32x16_bf16 v[168:183], v[220:223], v[100:103], 0
    v_and_or_b32 v252, v244, s65, v22
    buffer_load_dwordx4 v[220:223], v252, s[20:23], 0 offen nt
    v_exp_f32 v38, v158
    v_exp_f32 v39, v159
    v_exp_f32 v40, v160
    v_mfma_f32_32x32x16_bf16 v[168:183], v[200:203], v[108:111], v[168:183]
    v_exp_f32 v41, v161
    v_exp_f32 v42, v162
    v_exp_f32 v43, v163
    v_mfma_f32_32x32x16_bf16 v[168:183], v[204:207], v[116:119], v[168:183]
    v_exp_f32 v44, v164
    v_exp_f32 v45, v165
    v_exp_f32 v46, v166
    v_exp_f32 v47, v167
    v_and_b32 v253, 31, v245
    v_lshl_add_u32 v247, v253, 4, v25
    v_lshl_add_u32 v246, v253, 4, v26
    ds_read_b128 v[200:203], v247
    ds_read_b128 v[204:207], v247 offset:832
    ds_read_b128 v[248:251], v23
    v_pk_add_f32 v[32:33], v[32:33], s[62:63]
    v_pk_add_f32 v[34:35], v[34:35], s[62:63]
    v_pk_add_f32 v[36:37], v[36:37], s[62:63]
    v_pk_add_f32 v[38:39], v[38:39], s[62:63]
    v_pk_add_f32 v[40:41], v[40:41], s[62:63]
    v_pk_add_f32 v[42:43], v[42:43], s[62:63]
    v_pk_add_f32 v[44:45], v[44:45], s[62:63]
    v_pk_add_f32 v[46:47], v[46:47], s[62:63]
    v_mfma_f32_32x32x16_bf16 v[168:183], v[184:187], v[68:71], v[168:183]
    s_waitcnt vmcnt(10)
    ds_read_b128 v[184:187], v16 offset:8192
    v_rcp_f32 v32, v32
    v_rcp_f32 v33, v33
    v_rcp_f32 v34, v34
    v_mfma_f32_32x32x16_bf16 v[168:183], v[188:191], v[76:79], v[168:183]
    ds_read_b128 v[188:191], v17 offset:8192
    v_rcp_f32 v35, v35
    v_rcp_f32 v36, v36
    v_rcp_f32 v37, v37
    v_mfma_f32_32x32x16_bf16 v[168:183], v[192:195], v[84:87], v[168:183]
    ds_read_b128 v[192:195], v18 offset:8192
    v_rcp_f32 v38, v38
    v_rcp_f32 v39, v39
    v_rcp_f32 v40, v40
    v_mfma_f32_32x32x16_bf16 v[168:183], v[196:199], v[92:95], v[168:183]
    ds_read_b128 v[196:199], v19 offset:8192
    v_rcp_f32 v41, v41
    v_rcp_f32 v42, v42
    v_rcp_f32 v43, v43
    v_rcp_f32 v44, v44
    v_rcp_f32 v45, v45
    v_rcp_f32 v46, v46
    v_rcp_f32 v47, v47
    v_add_u32 v23, 0x80, v23
    v_add_u32 v24, 0x80, v24
    v_pk_mul_f32 v[32:33], v[152:153], v[32:33]
    v_pk_mul_f32 v[34:35], v[154:155], v[34:35]
    v_pk_mul_f32 v[36:37], v[156:157], v[36:37]
    v_pk_mul_f32 v[38:39], v[158:159], v[38:39]
    v_pk_mul_f32 v[40:41], v[160:161], v[40:41]
    v_pk_mul_f32 v[42:43], v[162:163], v[42:43]
    v_pk_mul_f32 v[44:45], v[164:165], v[44:45]
    v_pk_mul_f32 v[46:47], v[166:167], v[46:47]
    v_cvt_pk_bf16_f32 v228, v32, v33
    v_cvt_pk_bf16_f32 v229, v34, v35
    v_cvt_pk_bf16_f32 v230, v36, v37
    v_cvt_pk_bf16_f32 v231, v38, v39
    v_cvt_pk_bf16_f32 v232, v40, v41
    v_cvt_pk_bf16_f32 v233, v42, v43
    v_cvt_pk_bf16_f32 v234, v44, v45
    v_cvt_pk_bf16_f32 v235, v46, v47
    s_waitcnt lgkmcnt(0)
    v_mfma_f32_32x32x16_bf16 v[152:167], v[224:227], v[96:99], 0
    ds_read_b32 v244, v24 offset:384
    ds_read_b32 v245, v24 offset:128
    s_cmp_lt_u32 s49, s48
    s_cselect_b32 s18, 0x61a800, 0
    s_cselect_b32 s22, 0x186a000, 0
    s_add_u32 s49, s49, 1
    v_exp_f32 v32, v168
    v_exp_f32 v33, v169
    v_exp_f32 v34, v170
    v_mfma_f32_32x32x16_bf16 v[152:167], v[200:203], v[104:107], v[152:167]
    s_add_u32 m0, s41, 8192
    v_and_or_b32 v248, v248, s64, v20
    buffer_load_dwordx4 v248, s[16:19], 0 offen lds
    v_exp_f32 v35, v171
    v_exp_f32 v36, v172
    v_exp_f32 v37, v173
    v_mfma_f32_32x32x16_bf16 v[152:167], v[204:207], v[112:115], v[152:167]
    s_add_u32 m0, s41, 9216
    v_and_or_b32 v249, v249, s64, v21
    buffer_load_dwordx4 v249, s[16:19], 0 offen lds
    v_exp_f32 v38, v174
    v_exp_f32 v39, v175
    v_exp_f32 v40, v176
    v_mfma_f32_32x32x16_bf16 v[152:167], v[184:187], v[64:67], v[152:167]
    s_add_u32 m0, s41, 10240
    v_and_or_b32 v250, v250, s64, v20
    buffer_load_dwordx4 v250, s[16:19], 0 offen lds
    v_exp_f32 v41, v177
    v_exp_f32 v42, v178
    v_exp_f32 v43, v179
    v_mfma_f32_32x32x16_bf16 v[152:167], v[188:191], v[72:75], v[152:167]
    s_add_u32 m0, s41, 11264
    v_and_or_b32 v251, v251, s64, v21
    buffer_load_dwordx4 v251, s[16:19], 0 offen lds
    v_exp_f32 v44, v180
    v_exp_f32 v45, v181
    v_exp_f32 v46, v182
    v_exp_f32 v47, v183
    v_pk_add_f32 v[32:33], v[32:33], s[62:63]
    v_pk_add_f32 v[34:35], v[34:35], s[62:63]
    v_pk_add_f32 v[36:37], v[36:37], s[62:63]
    v_pk_add_f32 v[38:39], v[38:39], s[62:63]
    v_pk_add_f32 v[40:41], v[40:41], s[62:63]
    v_pk_add_f32 v[42:43], v[42:43], s[62:63]
    v_pk_add_f32 v[44:45], v[44:45], s[62:63]
    v_pk_add_f32 v[46:47], v[46:47], s[62:63]
    v_mfma_f32_32x32x16_bf16 v[152:167], v[192:195], v[80:83], v[152:167]
    v_rcp_f32 v32, v32
    v_rcp_f32 v33, v33
    v_rcp_f32 v34, v34
    v_mfma_f32_32x32x16_bf16 v[152:167], v[196:199], v[88:91], v[152:167]
    v_rcp_f32 v35, v35
    v_rcp_f32 v36, v36
    v_rcp_f32 v37, v37
    v_mfma_f32_32x32x16_bf16 v[120:135], v[228:231], v[208:211], v[120:135]
    v_rcp_f32 v38, v38
    v_rcp_f32 v39, v39
    v_rcp_f32 v40, v40
    v_mfma_f32_32x32x16_bf16 v[120:135], v[232:235], v[212:215], v[120:135]
    v_rcp_f32 v41, v41
    v_rcp_f32 v42, v42
    v_rcp_f32 v43, v43
    v_rcp_f32 v44, v44
    v_rcp_f32 v45, v45
    v_rcp_f32 v46, v46
    v_rcp_f32 v47, v47
    s_waitcnt lgkmcnt(0)
    v_pk_mul_f32 v[32:33], v[168:169], v[32:33]
    v_pk_mul_f32 v[34:35], v[170:171], v[34:35]
    v_pk_mul_f32 v[36:37], v[172:173], v[36:37]
    v_pk_mul_f32 v[38:39], v[174:175], v[38:39]
    v_pk_mul_f32 v[40:41], v[176:177], v[40:41]
    v_pk_mul_f32 v[42:43], v[178:179], v[42:43]
    v_pk_mul_f32 v[44:45], v[180:181], v[44:45]
    v_pk_mul_f32 v[46:47], v[182:183], v[46:47]
    v_cvt_pk_bf16_f32 v236, v32, v33
    v_cvt_pk_bf16_f32 v237, v34, v35
    v_cvt_pk_bf16_f32 v238, v36, v37
    v_cvt_pk_bf16_f32 v239, v38, v39
    v_cvt_pk_bf16_f32 v240, v40, v41
    v_cvt_pk_bf16_f32 v241, v42, v43
    v_cvt_pk_bf16_f32 v242, v44, v45
    v_cvt_pk_bf16_f32 v243, v46, v47
    s_cmp_lg_u32 s66, s67
    s_cbranch_scc1 L_pk1
    s_setprio 0
L_pk1:
    s_sub_u32 s66, s66, 1
    s_cmp_eq_u32 s66, 0
    s_cbranch_scc1 L2_loop_done
    v_mfma_f32_32x32x16_bf16 v[136:151], v[236:239], v[208:211], v[136:151]
    ds_write_b16 v246, v28
    v_exp_f32 v32, v152
    v_exp_f32 v33, v153
    v_exp_f32 v34, v154
    v_mfma_f32_32x32x16_bf16 v[136:151], v[240:243], v[212:215], v[136:151]
    ds_read_b128 v[208:211], v27
    ds_read_b128 v[212:215], v27 offset:832
    ds_write_b16 v246, v29
    v_exp_f32 v35, v155
    v_exp_f32 v36, v156
    v_exp_f32 v37, v157
    v_mfma_f32_32x32x16_bf16 v[168:183], v[224:227], v[100:103], 0
    v_and_or_b32 v252, v244, s65, v22
    buffer_load_dwordx4 v[224:227], v252, s[20:23], 0 offen nt
    v_exp_f32 v38, v158
    v_exp_f32 v39, v159
    v_exp_f32 v40, v160
    v_mfma_f32_32x32x16_bf16 v[168:183], v[200:203], v[108:111], v[168:183]
    v_exp_f32 v41, v161
    v_exp_f32 v42, v162
    v_exp_f32 v43, v163
    v_mfma_f32_32x32x16_bf16 v[168:183], v[204:207], v[116:119], v[168:183]
    v_exp_f32 v44, v164
    v_exp_f32 v45, v165
    v_exp_f32 v46, v166
    v_exp_f32 v47, v167
    v_and_b32 v253, 31, v245
    v_lshl_add_u32 v247, v253, 4, v25
    v_lshl_add_u32 v246, v253, 4, v26
    ds_read_b128 v[200:203], v247
    ds_read_b128 v[204:207], v247 offset:832
    ds_read_b128 v[248:251], v23
    v_pk_add_f32 v[32:33], v[32:33], s[62:63]
    v_pk_add_f32 v[34:35], v[34:35], s[62:63]
    v_pk_add_f32 v[36:37], v[36:37], s[62:63]
    v_pk_add_f32 v[38:39], v[38:39], s[62:63]
    v_pk_add_f32 v[40:41], v[40:41], s[62:63]
    v_pk_add_f32 v[42:43], v[42:43], s[62:63]
    v_pk_add_f32 v[44:45], v[44:45], s[62:63]
    v_pk_add_f32 v[46:47], v[46:47], s[62:63]
    v_mfma_f32_32x32x16_bf16 v[168:183], v[184:187], v[68:71], v[168:183]
    s_waitcnt vmcnt(10)
    ds_read_b128 v[184:187], v16 offset:0
    v_rcp_f32 v32, v32
    v_rcp_f32 v33, v33
    v_rcp_f32 v34, v34
    v_mfma_f32_32x32x16_bf16 v[168:183], v[188:191], v[76:79], v[168:183]
    ds_read_b128 v[188:191], v17 offset:0
    v_rcp_f32 v35, v35
    v_rcp_f32 v36, v36
    v_rcp_f32 v37, v37
    v_mfma_f32_32x32x16_bf16 v[168:183], v[192:195], v[84:87], v[168:183]
    ds_read_b128 v[192:195], v18 offset:0
    v_rcp_f32 v38, v38
    v_rcp_f32 v39, v39
    v_rcp_f32 v40, v40
    v_mfma_f32_32x32x16_bf16 v[168:183], v[196:199], v[92:95], v[168:183]
    ds_read_b128 v[196:199], v19 offset:0
    v_rcp_f32 v41, v41
    v_rcp_f32 v42, v42
    v_rcp_f32 v43, v43
    v_rcp_f32 v44, v44
    v_rcp_f32 v45, v45
    v_rcp_f32 v46, v46
    v_rcp_f32 v47, v47
    v_add_u32 v23, 0x80, v23
    v_add_u32 v24, 0x80, v24
    v_pk_mul_f32 v[32:33], v[152:153], v[32:33]
    v_pk_mul_f32 v[34:35], v[154:155], v[34:35]
    v_pk_mul_f32 v[36:37], v[156:157], v[36:37]
    v_pk_mul_f32 v[38:39], v[158:159], v[38:39]
    v_pk_mul_f32 v[40:41], v[160:161], v[40:41]
    v_pk_mul_f32 v[42:43], v[162:163], v[42:43]
    v_pk_mul_f32 v[44:45], v[164:165], v[44:45]
    v_pk_mul_f32 v[46:47], v[166:167], v[46:47]
    v_cvt_pk_bf16_f32 v228, v32, v33
    v_cvt_pk_bf16_f32 v229, v34, v35
    v_cvt_pk_bf16_f32 v230, v36, v37
    v_cvt_pk_bf16_f32 v231, v38, v39
    v_cvt_pk_bf16_f32 v232, v40, v41
    v_cvt_pk_bf16_f32 v233, v42, v43
    v_cvt_pk_bf16_f32 v234, v44, v45
    v_cvt_pk_bf16_f32 v235, v46, v47
    s_waitcnt lgkmcnt(0)
    v_mfma_f32_32x32x16_bf16 v[152:167], v[216:219], v[96:99], 0
    ds_read_b32 v244, v24 offset:384
    ds_read_b32 v245, v24 offset:128
    s_cmp_lt_u32 s49, s48
    s_cselect_b32 s18, 0x61a800, 0
    s_cselect_b32 s22, 0x186a000, 0
    s_add_u32 s49, s49, 1
    v_exp_f32 v32, v168
    v_exp_f32 v33, v169
    v_exp_f32 v34, v170
    v_mfma_f32_32x32x16_bf16 v[152:167], v[200:203], v[104:107], v[152:167]
    s_add_u32 m0, s41, 0
    v_and_or_b32 v248, v248, s64, v20
    buffer_load_dwordx4 v248, s[16:19], 0 offen lds
    v_exp_f32 v35, v171
    v_exp_f32 v36, v172
    v_exp_f32 v37, v173
    v_mfma_f32_32x32x16_bf16 v[152:167], v[204:207], v[112:115], v[152:167]
    s_add_u32 m0, s41, 1024
    v_and_or_b32 v249, v249, s64, v21
    buffer_load_dwordx4 v249, s[16:19], 0 offen lds
    v_exp_f32 v38, v174
    v_exp_f32 v39, v175
    v_exp_f32 v40, v176
    v_mfma_f32_32x32x16_bf16 v[152:167], v[184:187], v[64:67], v[152:167]
    s_add_u32 m0, s41, 2048
    v_and_or_b32 v250, v250, s64, v20
    buffer_load_dwordx4 v250, s[16:19], 0 offen lds
    v_exp_f32 v41, v177
    v_exp_f32 v42, v178
    v_exp_f32 v43, v179
    v_mfma_f32_32x32x16_bf16 v[152:167], v[188:191], v[72:75], v[152:167]
    s_add_u32 m0, s41, 3072
    v_and_or_b32 v251, v251, s64, v21
    buffer_load_dwordx4 v251, s[16:19], 0 offen lds
    v_exp_f32 v44, v180
    v_exp_f32 v45, v181
    v_exp_f32 v46, v182
    v_exp_f32 v47, v183
    v_pk_add_f32 v[32:33], v[32:33], s[62:63]
    v_pk_add_f32 v[34:35], v[34:35], s[62:63]
    v_pk_add_f32 v[36:37], v[36:37], s[62:63]
    v_pk_add_f32 v[38:39], v[38:39], s[62:63]
    v_pk_add_f32 v[40:41], v[40:41], s[62:63]
    v_pk_add_f32 v[42:43], v[42:43], s[62:63]
    v_pk_add_f32 v[44:45], v[44:45], s[62:63]
    v_pk_add_f32 v[46:47], v[46:47], s[62:63]
    v_mfma_f32_32x32x16_bf16 v[152:167], v[192:195], v[80:83], v[152:167]
    v_rcp_f32 v32, v32
    v_rcp_f32 v33, v33
    v_rcp_f32 v34, v34
    v_mfma_f32_32x32x16_bf16 v[152:167], v[196:199], v[88:91], v[152:167]
    v_rcp_f32 v35, v35
    v_rcp_f32 v36, v36
    v_rcp_f32 v37, v37
    v_mfma_f32_32x32x16_bf16 v[120:135], v[228:231], v[208:211], v[120:135]
    v_rcp_f32 v38, v38
    v_rcp_f32 v39, v39
    v_rcp_f32 v40, v40
    v_mfma_f32_32x32x16_bf16 v[120:135], v[232:235], v[212:215], v[120:135]
    v_rcp_f32 v41, v41
    v_rcp_f32 v42, v42
    v_rcp_f32 v43, v43
    v_rcp_f32 v44, v44
    v_rcp_f32 v45, v45
    v_rcp_f32 v46, v46
    v_rcp_f32 v47, v47
    s_waitcnt lgkmcnt(0)
    v_pk_mul_f32 v[32:33], v[168:169], v[32:33]
    v_pk_mul_f32 v[34:35], v[170:171], v[34:35]
    v_pk_mul_f32 v[36:37], v[172:173], v[36:37]
    v_pk_mul_f32 v[38:39], v[174:175], v[38:39]
    v_pk_mul_f32 v[40:41], v[176:177], v[40:41]
    v_pk_mul_f32 v[42:43], v[178:179], v[42:43]
    v_pk_mul_f32 v[44:45], v[180:181], v[44:45]
    v_pk_mul_f32 v[46:47], v[182:183], v[46:47]
    v_cvt_pk_bf16_f32 v236, v32, v33
    v_cvt_pk_bf16_f32 v237, v34, v35
    v_cvt_pk_bf16_f32 v238, v36, v37
    v_cvt_pk_bf16_f32 v239, v38, v39
    v_cvt_pk_bf16_f32 v240, v40, v41
    v_cvt_pk_bf16_f32 v241, v42, v43
    v_cvt_pk_bf16_f32 v242, v44, v45
    v_cvt_pk_bf16_f32 v243, v46, v47
    s_cmp_lg_u32 s66, s67
    s_cbranch_scc1 L_pk2
    s_setprio 0
L_pk2:
    s_sub_u32 s66, s66, 1
    s_cmp_eq_u32 s66, 0
    s_cbranch_scc0 L2_loop
L2_loop_done:
    v_mfma_f32_32x32x16_bf16 v[136:151], v[236:239], v[208:211], v[136:151]
    v_mfma_f32_32x32x16_bf16 v[136:151], v[240:243], v[212:215], v[136:151]
L2_loop_skip:
L2_tiles_done:
    s_cmp_eq_u32 s53, 0
    s_cbranch_scc1 L2_epi
    s_add_u32 s50, s50, 2
    s_cmp_ge_u32 s50, s59
    s_cbranch_scc1 L2_epi
    s_lshl_b32 s3, s12, 2
    s_add_u32 s3, s3, s56
    v_mov_b32 v252, s3
    ds_write_b32 v252, v29
    s_mov_b32 s49, 0
    s_waitcnt vmcnt(0) lgkmcnt(0)
    s_barrier
    s_branch L_retab
L2_epi:
    v_and_b32 v252, 1, v1
    v_lshlrev_b32 v252, 6, v252
    v_bfe_u32 v253, v1, 1, 1
    v_lshl_add_u32 v252, v253, 3, v252
    v_and_b32 v253, 16, v1
    v_add_u32 v252, v252, v253
    v_bfe_u32 v253, v1, 2, 2
    v_lshl_add_u32 v252, v253, 7, v252
    v_lshl_add_u32 v253, v4, 10, v252
    v_lshl_add_u32 v254, v4, 9, v252
    v_add_u32 v252, 131072, v253
    v_add_u32 v253, 131072, v253
    v_add_u32 v254, 131072, v254
    s_waitcnt vmcnt(0) lgkmcnt(0)
    ds_read_b64_tr_b16 v[64:65], v252 offset:0
    ds_read_b64_tr_b16 v[66:67], v252 offset:512
    ds_read_b64_tr_b16 v[68:69], v252 offset:32
    ds_read_b64_tr_b16 v[70:71], v252 offset:544
    ds_read_b64_tr_b16 v[72:73], v252 offset:2048
    ds_read_b64_tr_b16 v[74:75], v252 offset:2560
    ds_read_b64_tr_b16 v[76:77], v252 offset:2080
    ds_read_b64_tr_b16 v[78:79], v252 offset:2592
    ds_read_b64_tr_b16 v[80:81], v253 offset:4096
    ds_read_b64_tr_b16 v[82:83], v253 offset:4608
    ds_read_b64_tr_b16 v[84:85], v253 offset:4128
    ds_read_b64_tr_b16 v[86:87], v253 offset:4640
    s_waitcnt lgkmcnt(8)
    ds_read_b64_tr_b16 v[88:89], v253 offset:6144
    ds_read_b64_tr_b16 v[90:91], v253 offset:6656
    ds_read_b64_tr_b16 v[92:93], v253 offset:6176
    ds_read_b64_tr_b16 v[94:95], v253 offset:6688
    s_mov_b32 s60, 0xbf317218
    s_mov_b32 s61, 0xbf317218
    v_pk_mul_f32 v[120:121], v[120:121], s[60:61]
    v_pk_mul_f32 v[122:123], v[122:123], s[60:61]
    v_pk_mul_f32 v[124:125], v[124:125], s[60:61]
    v_pk_mul_f32 v[126:127], v[126:127], s[60:61]
    v_pk_mul_f32 v[128:129], v[128:129], s[60:61]
    v_pk_mul_f32 v[130:131], v[130:131], s[60:61]
    v_pk_mul_f32 v[132:133], v[132:133], s[60:61]
    v_pk_mul_f32 v[134:135], v[134:135], s[60:61]
    v_pk_mul_f32 v[136:137], v[136:137], s[60:61]
    v_pk_mul_f32 v[138:139], v[138:139], s[60:61]
    v_pk_mul_f32 v[140:141], v[140:141], s[60:61]
    v_pk_mul_f32 v[142:143], v[142:143], s[60:61]
    v_pk_mul_f32 v[144:145], v[144:145], s[60:61]
    v_pk_mul_f32 v[146:147], v[146:147], s[60:61]
    v_pk_mul_f32 v[148:149], v[148:149], s[60:61]
    v_pk_mul_f32 v[150:151], v[150:151], s[60:61]
    s_mov_b32 s60, 0xbfb8aa3b
    s_mov_b32 s61, 0xbfb8aa3b
    v_cvt_pk_bf16_f32 v228, v120, v121
    v_cvt_pk_bf16_f32 v229, v122, v123
    v_cvt_pk_bf16_f32 v230, v124, v125
    v_cvt_pk_bf16_f32 v231, v126, v127
    v_cvt_pk_bf16_f32 v232, v128, v129
    v_cvt_pk_bf16_f32 v233, v130, v131
    v_cvt_pk_bf16_f32 v234, v132, v133
    v_cvt_pk_bf16_f32 v235, v134, v135
    v_cvt_pk_bf16_f32 v236, v136, v137
    v_cvt_pk_bf16_f32 v237, v138, v139
    v_cvt_pk_bf16_f32 v238, v140, v141
    v_cvt_pk_bf16_f32 v239, v142, v143
    v_cvt_pk_bf16_f32 v240, v144, v145
    v_cvt_pk_bf16_f32 v241, v146, v147
    v_cvt_pk_bf16_f32 v242, v148, v149
    v_cvt_pk_bf16_f32 v243, v150, v151
    s_waitcnt lgkmcnt(0)
    ds_read_b64_tr_b16 v[184:185], v254 offset:8192
    ds_read_b64_tr_b16 v[186:187], v254 offset:9216
    ds_read_b64_tr_b16 v[188:189], v254 offset:8224
    ds_read_b64_tr_b16 v[190:191], v254 offset:9248
    ds_read_b64_tr_b16 v[192:193], v254 offset:10240
    ds_read_b64_tr_b16 v[194:195], v254 offset:11264
    ds_read_b64_tr_b16 v[196:197], v254 offset:10272
    ds_read_b64_tr_b16 v[198:199], v254 offset:11296
    ds_read_b64_tr_b16 v[200:201], v254 offset:12288
    ds_read_b64_tr_b16 v[202:203], v254 offset:13312
    ds_read_b64_tr_b16 v[204:205], v254 offset:12320
    ds_read_b64_tr_b16 v[206:207], v254 offset:13344
    s_waitcnt lgkmcnt(8)
    ds_read_b64_tr_b16 v[208:209], v254 offset:14336
    ds_read_b64_tr_b16 v[210:211], v254 offset:15360
    ds_read_b64_tr_b16 v[212:213], v254 offset:14368
    ds_read_b64_tr_b16 v[214:215], v254 offset:15392
    v_mfma_f32_32x32x16_bf16 v[152:167], v[64:67], v[48:51], 0
    v_mfma_f32_32x32x16_bf16 v[152:167], v[72:75], v[52:55], v[152:167]
    v_mfma_f32_32x32x16_bf16 v[152:167], v[80:83], v[56:59], v[152:167]
    v_mfma_f32_32x32x16_bf16 v[152:167], v[88:91], v[60:63], v[152:167]
    v_mfma_f32_32x32x16_bf16 v[168:183], v[68:71], v[48:51], 0
    v_mfma_f32_32x32x16_bf16 v[168:183], v[76:79], v[52:55], v[168:183]
    v_mfma_f32_32x32x16_bf16 v[168:183], v[84:87], v[56:59], v[168:183]
    v_mfma_f32_32x32x16_bf16 v[168:183], v[92:95], v[60:63], v[168:183]
    s_waitcnt lgkmcnt(0)
    v_mfma_f32_32x32x16_bf16 v[152:167], v[184:187], v[228:231], v[152:167]
    v_mfma_f32_32x32x16_bf16 v[152:167], v[192:195], v[232:235], v[152:167]
    v_mfma_f32_32x32x16_bf16 v[152:167], v[200:203], v[236:239], v[152:167]
    v_mfma_f32_32x32x16_bf16 v[152:167], v[208:211], v[240:243], v[152:167]
    v_mfma_f32_32x32x16_bf16 v[168:183], v[188:191], v[228:231], v[168:183]
    v_mfma_f32_32x32x16_bf16 v[168:183], v[196:199], v[232:235], v[168:183]
    v_mfma_f32_32x32x16_bf16 v[168:183], v[204:207], v[236:239], v[168:183]
    v_mfma_f32_32x32x16_bf16 v[168:183], v[212:215], v[240:243], v[168:183]
    s_mov_b32 s24, s78
    s_mov_b32 s25, s79
    s_mov_b32 s26, 0x61a800
    s_mov_b32 s27, 0x20000
    v_lshl_add_u32 v253, v4, 6, v7
    s_nop 3
    v_pk_mul_f32 v[32:33], v[152:153], s[60:61]
    v_pk_mul_f32 v[34:35], v[154:155], s[60:61]
    v_pk_mul_f32 v[36:37], v[156:157], s[60:61]
    v_pk_mul_f32 v[38:39], v[158:159], s[60:61]
    v_pk_mul_f32 v[40:41], v[160:161], s[60:61]
    v_pk_mul_f32 v[42:43], v[162:163], s[60:61]
    v_pk_mul_f32 v[44:45], v[164:165], s[60:61]
    v_pk_mul_f32 v[46:47], v[166:167], s[60:61]
    v_exp_f32 v32, v32
    v_exp_f32 v33, v33
    v_exp_f32 v34, v34
    v_exp_f32 v35, v35
    v_exp_f32 v36, v36
    v_exp_f32 v37, v37
    v_exp_f32 v38, v38
    v_exp_f32 v39, v39
    v_exp_f32 v40, v40
    v_exp_f32 v41, v41
    v_exp_f32 v42, v42
    v_exp_f32 v43, v43
    v_exp_f32 v44, v44
    v_exp_f32 v45, v45
    v_exp_f32 v46, v46
    v_exp_f32 v47, v47
    v_pk_add_f32 v[32:33], v[32:33], s[62:63]
    v_pk_add_f32 v[34:35], v[34:35], s[62:63]
    v_pk_add_f32 v[36:37], v[36:37], s[62:63]
    v_pk_add_f32 v[38:39], v[38:39], s[62:63]
    v_pk_add_f32 v[40:41], v[40:41], s[62:63]
    v_pk_add_f32 v[42:43], v[42:43], s[62:63]
    v_pk_add_f32 v[44:45], v[44:45], s[62:63]
    v_pk_add_f32 v[46:47], v[46:47], s[62:63]
    v_rcp_f32 v32, v32
    v_rcp_f32 v33, v33
    v_rcp_f32 v34, v34
    v_rcp_f32 v35, v35
    v_rcp_f32 v36, v36
    v_rcp_f32 v37, v37
    v_rcp_f32 v38, v38
    v_rcp_f32 v39, v39
    v_rcp_f32 v40, v40
    v_rcp_f32 v41, v41
    v_rcp_f32 v42, v42
    v_rcp_f32 v43, v43
    v_rcp_f32 v44, v44
    v_rcp_f32 v45, v45
    v_rcp_f32 v46, v46
    v_rcp_f32 v47, v47
    v_pk_mul_f32 v[32:33], v[152:153], v[32:33]
    v_pk_mul_f32 v[34:35], v[154:155], v[34:35]
    v_pk_mul_f32 v[36:37], v[156:157], v[36:37]
    v_pk_mul_f32 v[38:39], v[158:159], v[38:39]
    v_pk_mul_f32 v[40:41], v[160:161], v[40:41]
    v_pk_mul_f32 v[42:43], v[162:163], v[42:43]
    v_pk_mul_f32 v[44:45], v[164:165], v[44:45]
    v_pk_mul_f32 v[46:47], v[166:167], v[46:47]
    v_cvt_pk_bf16_f32 v120, v32, v33
    v_cvt_pk_bf16_f32 v121, v34, v35
    v_cvt_pk_bf16_f32 v122, v36, v37
    v_cvt_pk_bf16_f32 v123, v38, v39
    v_cvt_pk_bf16_f32 v124, v40, v41
    v_cvt_pk_bf16_f32 v125, v42, v43
    v_cvt_pk_bf16_f32 v126, v44, v45
    v_cvt_pk_bf16_f32 v127, v46, v47
    v_pk_mul_f32 v[32:33], v[168:169], s[60:61]
    v_pk_mul_f32 v[34:35], v[170:171], s[60:61]
    v_pk_mul_f32 v[36:37], v[172:173], s[60:61]
    v_pk_mul_f32 v[38:39], v[174:175], s[60:61]
    v_pk_mul_f32 v[40:41], v[176:177], s[60:61]
    v_pk_mul_f32 v[42:43], v[178:179], s[60:61]
    v_pk_mul_f32 v[44:45], v[180:181], s[60:61]
    v_pk_mul_f32 v[46:47], v[182:183], s[60:61]
    v_exp_f32 v32, v32
    v_exp_f32 v33, v33
    v_exp_f32 v34, v34
    v_exp_f32 v35, v35
    v_exp_f32 v36, v36
    v_exp_f32 v37, v37
    v_exp_f32 v38, v38
    v_exp_f32 v39, v39
    v_exp_f32 v40, v40
    v_exp_f32 v41, v41
    v_exp_f32 v42, v42
    v_exp_f32 v43, v43
    v_exp_f32 v44, v44
    v_exp_f32 v45, v45
    v_exp_f32 v46, v46
    v_exp_f32 v47, v47
    v_pk_add_f32 v[32:33], v[32:33], s[62:63]
    v_pk_add_f32 v[34:35], v[34:35], s[62:63]
    v_pk_add_f32 v[36:37], v[36:37], s[62:63]
    v_pk_add_f32 v[38:39], v[38:39], s[62:63]
    v_pk_add_f32 v[40:41], v[40:41], s[62:63]
    v_pk_add_f32 v[42:43], v[42:43], s[62:63]
    v_pk_add_f32 v[44:45], v[44:45], s[62:63]
    v_pk_add_f32 v[46:47], v[46:47], s[62:63]
    v_rcp_f32 v32, v32
    v_rcp_f32 v33, v33
    v_rcp_f32 v34, v34
    v_rcp_f32 v35, v35
    v_rcp_f32 v36, v36
    v_rcp_f32 v37, v37
    v_rcp_f32 v38, v38
    v_rcp_f32 v39, v39
    v_rcp_f32 v40, v40
    v_rcp_f32 v41, v41
    v_rcp_f32 v42, v42
    v_rcp_f32 v43, v43
    v_rcp_f32 v44, v44
    v_rcp_f32 v45, v45
    v_rcp_f32 v46, v46
    v_rcp_f32 v47, v47
    v_pk_mul_f32 v[32:33], v[168:169], v[32:33]
    v_pk_mul_f32 v[34:35], v[170:171], v[34:35]
    v_pk_mul_f32 v[36:37], v[172:173], v[36:37]
    v_pk_mul_f32 v[38:39], v[174:175], v[38:39]
    v_pk_mul_f32 v[40:41], v[176:177], v[40:41]
    v_pk_mul_f32 v[42:43], v[178:179], v[42:43]
    v_pk_mul_f32 v[44:45], v[180:181], v[44:45]
    v_pk_mul_f32 v[46:47], v[182:183], v[46:47]
    v_cvt_pk_bf16_f32 v128, v32, v33
    v_cvt_pk_bf16_f32 v129, v34, v35
    v_cvt_pk_bf16_f32 v130, v36, v37
    v_cvt_pk_bf16_f32 v131, v38, v39
    v_cvt_pk_bf16_f32 v132, v40, v41
    v_cvt_pk_bf16_f32 v133, v42, v43
    v_cvt_pk_bf16_f32 v134, v44, v45
    v_cvt_pk_bf16_f32 v135, v46, v47
    s_or_b32 s3, s2, s12
    s_cbranch_scc1 L_noepo
    s_add_u32 s28, s76, 0x7c0000
    s_addc_u32 s29, s77, 0
    s_mov_b32 s30, 0x4
    s_mov_b32 s31, 0x20000
    v_mov_b32 v254, s10
    buffer_store_dword v254, v31, s[28:31], 0 offen
L_noepo:
    v_cmpx_gt_u32 vcc, s37, v3
    buffer_store_dwordx4 v[120:123], v253, s[24:27], s36 offen offset:0
    buffer_store_dwordx4 v[124:127], v253, s[24:27], s36 offen offset:16
    buffer_store_dwordx4 v[128:131], v253, s[24:27], s36 offen offset:32
    buffer_store_dwordx4 v[132:135], v253, s[24:27], s36 offen offset:48
L_end:
    s_endpgm
.section .rodata,"a"
.p2align 6
.amdhsa_kernel standalone__mpnn_edge_mlp__graph_kernel
  .amdhsa_next_free_vgpr 256
  .amdhsa_next_free_sgpr 102
  .amdhsa_accum_offset 256
  .amdhsa_group_segment_fixed_size 0
  .amdhsa_kernarg_size 72
  .amdhsa_user_sgpr_count 2
  .amdhsa_user_sgpr_kernarg_segment_ptr 1
  .amdhsa_system_sgpr_workgroup_id_x 1
.end_amdhsa_kernel
```
